```python
import torch

def _softmax(x, axis=-1):
    return torch.softmax(x, dim=axis)
def _gelu(x):
    return torch.nn.functional.gelu(x, approximate="tanh")
def _silu(x):
    return torch.nn.functional.silu(x)
def _sigmoid(x):
    return torch.sigmoid(x)
def _layernorm(x, axis=-1, eps=1e-5):
    m = x.mean(dim=axis, keepdim=True)
    v = x.var(dim=axis, keepdim=True, unbiased=False)
    return (x - m) / torch.sqrt(v + eps)
def _scatter_add(tgt, idx, src, axis=0):
    return tgt.clone().index_add_(axis, idx, src)
def _segment_sum(src, seg, n):
    out = torch.zeros((n,) + src.shape[1:], dtype=src.dtype)
    return out.index_add_(0, seg, src)
def _pad(x, pw):
    flat = tuple(v for pair in reversed(pw) for v in pair)
    return torch.nn.functional.pad(x, flat)

kernel_name = 'recurrent_scan__mha_block__glu_gated_swiglu__prompt'

def setup_inputs():

    _w = (lambda a: (lambda t: t.to(torch.bfloat16) if t.is_floating_point() else t)(torch.as_tensor(a)))
    def _A_setup():
        B, S, D, H = 1, 2048, 640, 32
        return {
            "x": _w((lambda *s: torch.randn(*s, dtype=torch.bfloat16) * 0.05)(B, S, D)),
            "wqkv": _w((lambda *s: torch.randn(*s, dtype=torch.bfloat16) * 0.2)(D, 3 * D)),
            "wo": _w((lambda *s: torch.randn(*s, dtype=torch.bfloat16) * 0.2)(D, D)),
        }
    _A_in = _A_setup()

    def _B_setup():
        B, S, D, F = 1, 2048, 640, 1536
        return {
            "x": _w((lambda *s: torch.randn(*s, dtype=torch.bfloat16) * 0.05)(B, S, D)),
            "w1": _w((lambda *s: torch.randn(*s, dtype=torch.bfloat16) * 0.1)(D, F) * (2.0 / D) ** 0.5),
            "w3": _w((lambda *s: torch.randn(*s, dtype=torch.bfloat16) * 0.1)(D, F) * (2.0 / D) ** 0.5),
            "w2": _w((lambda *s: torch.randn(*s, dtype=torch.bfloat16) * 0.1)(F, D) * (2.0 / F) ** 0.5),
        }
    _B_in = _B_setup()

    return {
        "A_x": _A_in["x"],
        "A_wqkv": _A_in["wqkv"],
        "A_wo": _A_in["wo"],
        "B_x": _B_in["x"],
        "B_w1": _B_in["w1"],
        "B_w3": _B_in["w3"],
        "B_w2": _B_in["w2"],
    }

def reference(A_x, A_wqkv, A_wo, B_x, B_w1, B_w3, B_w2):
    def _A_ref(x, wqkv, wo):
        B, S, D = x.shape
        H = 32
        Dh = D // H
        qkv = (lambda x, *d: x.permute(*d))((x @ wqkv).reshape(B, S, 3, H, Dh), 2, 0, 3, 1, 4)
        q, k, v = qkv[0], qkv[1], qkv[2]
        scores = torch.einsum("bhqd,bhkd->bhqk", q, k) * (Dh ** -0.5)
        p = _softmax(scores, axis=-1)
        o = torch.einsum("bhqk,bhkd->bhqd", p, v)
        return (lambda x, *d: x.permute(*d))(o, 0, 2, 1, 3).reshape(B, S, D) @ wo

    def _B_ref(x, w1, w3, w2):
        gate = torch.einsum("bsd,df->bsf", x, w1)
        up = torch.einsum("bsd,df->bsf", x, w3)
        h = _silu(gate) * up
        out = torch.einsum("bsf,fd->bsd", h, w2)
        return out

    x = A_x
    xn = _layernorm(x, axis=-1)
    s = _A_ref(xn, A_wqkv, A_wo)
    g = _silu(_B_ref(xn, B_w1, B_w3, B_w2))
    return x + s * g
```

```asm
; @launch kernel=recurrent_scan__mha_block__glu_gated_swiglu__prompt_kernel grid=(256,1,1) block=(768,1,1) lds=163840
; @launch kernel=attn_kernel grid=(256,1,1) block=(768,1,1) lds=133376
.amdgcn_target "amdgcn-amd-amdhsa--gfx950"
.text
.globl recurrent_scan__mha_block__glu_gated_swiglu__prompt_kernel
.p2align 8
.type recurrent_scan__mha_block__glu_gated_swiglu__prompt_kernel,@function
recurrent_scan__mha_block__glu_gated_swiglu__prompt_kernel:
    s_cmp_ge_u32 s2, 256
    s_cbranch_scc1 L_END
    s_load_dwordx4 s[4:7], s[0:1], 0
    s_load_dwordx2 s[8:9], s[0:1], 16
    s_load_dwordx4 s[12:15], s[0:1], 32
    s_load_dwordx4 s[16:19], s[0:1], 48
    s_load_dwordx4 s[20:23], s[0:1], 64
    v_lshrrev_b32 v1, 6, v0
    v_and_b32 v0, 63, v0
    v_lshlrev_b32 v2, 2, v0
    v_add_u32 v2, 156544, v2
    v_mov_b32 v3, 0
    ds_write_b32 v2, v3
    s_and_b32 s52, s2, 7
    s_lshr_b32 s53, s2, 3
    v_readfirstlane_b32 s24, v1
    s_and_b32 s54, s52, 1
    s_lshl_b32 s54, s54, 3
    s_and_b32 s55, s53, 7
    s_add_u32 s25, s54, s55
    s_lshr_b32 s54, s52, 1
    s_lshl_b32 s54, s54, 2
    s_lshr_b32 s55, s53, 3
    s_add_u32 s26, s54, s55
    s_min_u32 s27, s26, 14
    s_and_b32 s28, s24, 3
    s_waitcnt lgkmcnt(0)
    s_mov_b32 s32, s22
    s_and_b32 s33, s23, 0xffff
    s_mov_b32 s34, 19693568
    s_mov_b32 s35, 0x00020000
    s_mov_b32 s36, s20
    s_and_b32 s37, s21, 0xffff
    s_mov_b32 s38, 256
    s_mov_b32 s39, 0x00020000
    s_or_b32 s52, s2, s24
    s_cmp_eq_u32 s52, 0
    s_cbranch_scc0 L_NOCNT
    v_lshlrev_b32 v2, 8, v0
    v_add_u32 v2, 0, v2
    v_mov_b32 v3, 0
    s_mov_b64 exec, 0xff
    buffer_store_dword v3, v2, s[32:35], 0 offen sc1
    s_mov_b64 exec, -1
L_NOCNT:
    s_cmp_lt_u32 s24, 4
    s_cbranch_scc0 L_NOPOIS
    s_mul_i32 s52, s2, 10240
    s_mul_i32 s53, s24, 2560
    s_add_u32 s52, s52, s53
    s_add_u32 s52, s52, 14286848
    v_lshlrev_b32 v2, 4, v0
    v_mov_b32 v4, -1
    v_mov_b32 v5, -1
    v_mov_b32 v6, -1
    v_mov_b32 v7, -1
    buffer_store_dwordx4 v[4:7], v2, s[32:35], s52 offen sc1
    buffer_store_dwordx4 v[4:7], v2, s[32:35], s52 offen offset:1024 sc1
    s_mov_b32 exec_hi, 0
    buffer_store_dwordx4 v[4:7], v2, s[32:35], s52 offen offset:2048 sc1
    s_mov_b64 exec, -1
    s_nop 1
L_NOPOIS:
    s_barrier
    s_cmp_lt_u32 s24, 4
    s_cbranch_scc1 L_ROLE_A
    s_cmp_lt_u32 s24, 8
    s_cbranch_scc1 L_ROLE_B
    s_setprio 3
    s_mov_b32 s40, s4
    s_and_b32 s41, s5, 0xffff
    s_mov_b32 s42, 2621440
    s_mov_b32 s43, 0x00020000
    s_lshl_b32 s52, s25, 7
    s_lshl_b32 s53, s28, 5
    s_add_u32 s52, s52, s53
    s_mul_i32 s52, s52, 1280
    v_lshrrev_b32 v10, 3, v0
    v_and_b32 v11, 7, v0
    v_lshrrev_b32 v12, 4, v0
    s_lshl_b32 s56, s28, 12
    v_xor_b32 v14, 0, v12
    v_xor_b32 v14, v14, v11

    v_add_u32 v15, 0, v10
    v_mul_u32_u24 v15, 1280, v15
    v_lshl_add_u32 v15, v14, 4, v15
    v_add_u32 v15, s52, v15
    v_subrev_u32 v2, 0, v15
    v_xor_b32 v14, 4, v12
    v_xor_b32 v14, v14, v11

    v_add_u32 v15, 8, v10
    v_mul_u32_u24 v15, 1280, v15
    v_lshl_add_u32 v15, v14, 4, v15
    v_add_u32 v15, s52, v15
    v_subrev_u32 v3, 1024, v15
    v_xor_b32 v14, 0, v12
    v_xor_b32 v14, v14, v11

    v_add_u32 v15, 16, v10
    v_mul_u32_u24 v15, 1280, v15
    v_lshl_add_u32 v15, v14, 4, v15
    v_add_u32 v15, s52, v15
    v_subrev_u32 v4, 2048, v15
    v_xor_b32 v14, 4, v12
    v_xor_b32 v14, v14, v11

    v_add_u32 v15, 24, v10
    v_mul_u32_u24 v15, 1280, v15
    v_lshl_add_u32 v15, v14, 4, v15
    v_add_u32 v15, s52, v15
    v_subrev_u32 v5, 3072, v15
    s_add_u32 m0, s56, 0
    s_mov_b32 s60, 0
    buffer_load_dwordx4 v2, s[40:43], s60 offen offset:0 lds
    buffer_load_dwordx4 v3, s[40:43], s60 offen offset:1024 lds
    buffer_load_dwordx4 v4, s[40:43], s60 offen offset:2048 lds
    buffer_load_dwordx4 v5, s[40:43], s60 offen offset:3072 lds
    s_mov_b32 s44, s6
    s_and_b32 s45, s7, 0xffff
    s_mov_b32 s46, 2457600
    s_mov_b32 s47, 0x00020000
    s_lshl_b32 s53, s28, 3
    s_lshl_b32 s54, s27, 8
    v_and_b32 v14, 15, v0
    v_lshlrev_b32 v15, 2, v12
    v_xor_b32 v14, v14, v15
    v_add_u32 v15, s53, v12
    v_mul_u32_u24 v15, 3840, v15
    v_lshl_add_u32 v15, v14, 4, v15
    v_add_u32 v6, s54, v15
    v_add_u32 v7, 14336, v6
    s_lshl_b32 s57, s28, 11
    s_add_u32 m0, s57, 49152
    s_mov_b32 s61, 0
    buffer_load_dwordx4 v6, s[44:47], s61 offen offset:0 lds
    buffer_load_dwordx4 v7, s[44:47], s61 offen offset:1024 lds
    s_lshr_b32 s53, s28, 1
    s_cmp_eq_u32 s53, 0
    s_cselect_b32 s48, s12, s14
    s_cselect_b32 s49, s13, s15
    s_and_b32 s49, s49, 0xffff
    s_mov_b32 s50, 1966080
    s_mov_b32 s51, 0x00020000
    s_mul_i32 s58, s53, 6176
    s_and_b32 s54, s28, 1
    s_mul_i32 s55, s54, 3072
    s_add_u32 s58, s58, s55
    s_mul_i32 s54, s54, 192
    s_mul_i32 s55, s26, 192
    v_add_u32 v14, 0, v0
    v_add_u32 v14, s54, v14
    v_mul_u32_u24 v15, 5462, v14
    v_lshrrev_b32 v15, 16, v15
    v_mul_u32_u24 v16, 12, v15
    v_sub_u32 v14, v14, v16
    v_mul_u32_u24 v15, 3072, v15
    v_lshl_add_u32 v15, v14, 4, v15
    v_add_u32 v15, s55, v15
    v_subrev_u32 v8, 0, v15
    v_add_u32 v14, 64, v0
    v_add_u32 v14, s54, v14
    v_mul_u32_u24 v15, 5462, v14
    v_lshrrev_b32 v15, 16, v15
    v_mul_u32_u24 v16, 12, v15
    v_sub_u32 v14, v14, v16
    v_mul_u32_u24 v15, 3072, v15
    v_lshl_add_u32 v15, v14, 4, v15
    v_add_u32 v15, s55, v15
    v_subrev_u32 v9, 1024, v15
    v_add_u32 v14, 128, v0
    v_add_u32 v14, s54, v14
    v_mul_u32_u24 v15, 5462, v14
    v_lshrrev_b32 v15, 16, v15
    v_mul_u32_u24 v16, 12, v15
    v_sub_u32 v14, v14, v16
    v_mul_u32_u24 v15, 3072, v15
    v_lshl_add_u32 v15, v14, 4, v15
    v_add_u32 v15, s55, v15
    v_subrev_u32 v13, 2048, v15
    s_add_u32 m0, s58, 90112
    s_mov_b32 s62, 0
    buffer_load_dwordx4 v8, s[48:51], s62 offen offset:0 lds
    buffer_load_dwordx4 v9, s[48:51], s62 offen offset:1024 lds
    buffer_load_dwordx4 v13, s[48:51], s62 offen offset:2048 lds
    s_add_u32 m0, s57, 57344
    s_mov_b32 s61, 122880
    buffer_load_dwordx4 v6, s[44:47], s61 offen offset:0 lds
    buffer_load_dwordx4 v7, s[44:47], s61 offen offset:1024 lds
    s_add_u32 m0, s58, 102464
    s_mov_b32 s62, 98304
    buffer_load_dwordx4 v8, s[48:51], s62 offen offset:0 lds
    buffer_load_dwordx4 v9, s[48:51], s62 offen offset:1024 lds
    buffer_load_dwordx4 v13, s[48:51], s62 offen offset:2048 lds
    v_and_b32 v20, 7, v0
    v_lshlrev_b32 v20, 2, v20
    v_add_u32 v20, 156560, v20
    s_lshl_b32 s53, s28, 2
    v_lshlrev_b32 v21, 2, v0
    v_add_u32 v21, 156672, v21
    s_add_u32 s52, s53, 156544
    v_mov_b32 v1, s52
    v_cmp_eq_u32 vcc, 0, v0
    v_cndmask_b32 v21, v21, v1, vcc
    v_and_b32 v14, 15, v0
    v_lshrrev_b32 v15, 4, v0
    v_bfe_u32 v16, v0, 1, 3
    s_lshl_b32 s52, s28, 12
    v_lshlrev_b32 v14, 7, v14
    v_add_u32 v14, s52, v14
    v_xor_b32 v17, v15, v16
    v_lshl_add_u32 v164, v17, 4, v14
    v_xor_b32 v17, 4, v17
    v_lshl_add_u32 v165, v17, 4, v14
    v_mov_b32 v144, 0
    v_mov_b32 v145, 0
    v_mov_b32 v146, 0
    v_mov_b32 v147, 0
    v_mov_b32 v148, 0
    v_mov_b32 v149, 0
    v_mov_b32 v150, 0
    v_mov_b32 v151, 0
    v_mov_b32 v152, 0
    v_mov_b32 v153, 0
    v_mov_b32 v154, 0
    v_mov_b32 v155, 0
    v_mov_b32 v156, 0
    v_mov_b32 v157, 0
    v_mov_b32 v158, 0
    v_mov_b32 v159, 0
    v_mov_b32 v160, 0x3f803f80
    v_mov_b32 v161, 0x3f803f80
    v_mov_b32 v162, 0x3f803f80
    v_mov_b32 v163, 0x3f803f80
    v_and_b32 v25, 7, v0
    v_cmp_gt_u32 vcc, 4, v25
    v_cndmask_b32 v25, 0, 1, vcc
    v_sub_u32 v26, 1, v25
    ds_read_b32 v23, v20
    s_waitcnt vmcnt(5)
    v_mov_b32 v22, 1
    ds_write_b32 v21, v22
    ds_read_b128 v[112:115], v164 offset:0
    ds_read_b128 v[116:119], v165 offset:0
    ds_read_b128 v[120:123], v164 offset:2048
    ds_read_b128 v[124:127], v165 offset:2048
    s_waitcnt lgkmcnt(0)
    s_add_u32 m0, s56, 16384
    s_mov_b32 s60, 128
    buffer_load_dwordx4 v2, s[40:43], s60 offen offset:0 lds
    buffer_load_dwordx4 v3, s[40:43], s60 offen offset:1024 lds
    buffer_load_dwordx4 v4, s[40:43], s60 offen offset:2048 lds
    buffer_load_dwordx4 v5, s[40:43], s60 offen offset:3072 lds
    s_add_u32 m0, s57, 65536
    s_mov_b32 s61, 245760
    buffer_load_dwordx4 v6, s[44:47], s61 offen offset:0 lds
    buffer_load_dwordx4 v7, s[44:47], s61 offen offset:1024 lds
    s_add_u32 m0, s58, 114816
    s_mov_b32 s62, 196608
    buffer_load_dwordx4 v8, s[48:51], s62 offen offset:0 lds
    buffer_load_dwordx4 v9, s[48:51], s62 offen offset:1024 lds
    buffer_load_dwordx4 v13, s[48:51], s62 offen offset:2048 lds
    v_mfma_f32_16x16x32_bf16 v[144:147], v[160:163], v[112:115], v[144:147]
    v_mfma_f32_16x16x32_bf16 v[152:155], v[112:115], v[112:115], v[152:155]
    v_mfma_f32_16x16x32_bf16 v[148:151], v[160:163], v[120:123], v[148:151]
    v_mfma_f32_16x16x32_bf16 v[156:159], v[120:123], v[120:123], v[156:159]
    v_mfma_f32_16x16x32_bf16 v[144:147], v[160:163], v[116:119], v[144:147]
    v_mfma_f32_16x16x32_bf16 v[152:155], v[116:119], v[116:119], v[152:155]
    v_mfma_f32_16x16x32_bf16 v[148:151], v[160:163], v[124:127], v[148:151]
    v_mfma_f32_16x16x32_bf16 v[156:159], v[124:127], v[124:127], v[156:159]
    s_waitcnt vmcnt(9)
    v_mov_b32 v22, 2
    ds_write_b32 v21, v22
    s_waitcnt lgkmcnt(0)
    s_add_u32 m0, s57, 73728
    s_mov_b32 s61, 368640
    buffer_load_dwordx4 v6, s[44:47], s61 offen offset:0 lds
    buffer_load_dwordx4 v7, s[44:47], s61 offen offset:1024 lds
    s_add_u32 m0, s58, 127168
    s_mov_b32 s62, 294912
    buffer_load_dwordx4 v8, s[48:51], s62 offen offset:0 lds
    buffer_load_dwordx4 v9, s[48:51], s62 offen offset:1024 lds
    buffer_load_dwordx4 v13, s[48:51], s62 offen offset:2048 lds
    s_waitcnt vmcnt(5)
    v_mov_b32 v22, 3
    ds_write_b32 v21, v22
    ds_read_b128 v[128:131], v164 offset:16384
    ds_read_b128 v[132:135], v165 offset:16384
    ds_read_b128 v[136:139], v164 offset:18432
    ds_read_b128 v[140:143], v165 offset:18432
    s_waitcnt lgkmcnt(0)
    s_add_u32 m0, s56, 32768
    s_mov_b32 s60, 256
    buffer_load_dwordx4 v2, s[40:43], s60 offen offset:0 lds
    buffer_load_dwordx4 v3, s[40:43], s60 offen offset:1024 lds
    buffer_load_dwordx4 v4, s[40:43], s60 offen offset:2048 lds
    buffer_load_dwordx4 v5, s[40:43], s60 offen offset:3072 lds
    s_add_u32 m0, s57, 81920
    s_mov_b32 s61, 491520
    buffer_load_dwordx4 v6, s[44:47], s61 offen offset:0 lds
    buffer_load_dwordx4 v7, s[44:47], s61 offen offset:1024 lds
    s_add_u32 m0, s58, 139520
    s_mov_b32 s62, 393216
    buffer_load_dwordx4 v8, s[48:51], s62 offen offset:0 lds
    buffer_load_dwordx4 v9, s[48:51], s62 offen offset:1024 lds
    buffer_load_dwordx4 v13, s[48:51], s62 offen offset:2048 lds
    v_mfma_f32_16x16x32_bf16 v[144:147], v[160:163], v[128:131], v[144:147]
    v_mfma_f32_16x16x32_bf16 v[152:155], v[128:131], v[128:131], v[152:155]
    v_mfma_f32_16x16x32_bf16 v[148:151], v[160:163], v[136:139], v[148:151]
    v_mfma_f32_16x16x32_bf16 v[156:159], v[136:139], v[136:139], v[156:159]
    v_mfma_f32_16x16x32_bf16 v[144:147], v[160:163], v[132:135], v[144:147]
    v_mfma_f32_16x16x32_bf16 v[152:155], v[132:135], v[132:135], v[152:155]
    v_mfma_f32_16x16x32_bf16 v[148:151], v[160:163], v[140:143], v[148:151]
    v_mfma_f32_16x16x32_bf16 v[156:159], v[140:143], v[140:143], v[156:159]
    s_waitcnt vmcnt(9)
    v_mov_b32 v22, 4
    ds_write_b32 v21, v22
    s_waitcnt lgkmcnt(0)
    v_mul_u32_u24 v24, 1, v25
    v_mad_u32_u24 v24, v26, 1, v24
    v_cmp_gt_u32 vcc, v24, v23
    s_cbranch_vccnz L_PF5_S
L_PF5_ok:
    ds_read_b32 v23, v20
    s_add_u32 m0, s57, 49152
    s_mov_b32 s61, 614400
    buffer_load_dwordx4 v6, s[44:47], s61 offen offset:0 lds
    buffer_load_dwordx4 v7, s[44:47], s61 offen offset:1024 lds
    s_add_u32 m0, s58, 90112
    s_mov_b32 s62, 491520
    buffer_load_dwordx4 v8, s[48:51], s62 offen offset:0 lds
    buffer_load_dwordx4 v9, s[48:51], s62 offen offset:1024 lds
    buffer_load_dwordx4 v13, s[48:51], s62 offen offset:2048 lds
    s_waitcnt vmcnt(5)
    v_mov_b32 v22, 5
    ds_write_b32 v21, v22
    ds_read_b128 v[112:115], v164 offset:32768
    ds_read_b128 v[116:119], v165 offset:32768
    ds_read_b128 v[120:123], v164 offset:34816
    ds_read_b128 v[124:127], v165 offset:34816
    s_waitcnt lgkmcnt(0)
    v_mul_u32_u24 v24, 2, v25
    v_mad_u32_u24 v24, v26, 2, v24
    v_cmp_gt_u32 vcc, v24, v23
    s_cbranch_vccnz L_PF6_S
L_PF6_ok:
    ds_read_b32 v23, v20
    s_add_u32 m0, s56, 0
    s_mov_b32 s60, 384
    buffer_load_dwordx4 v2, s[40:43], s60 offen offset:0 lds
    buffer_load_dwordx4 v3, s[40:43], s60 offen offset:1024 lds
    buffer_load_dwordx4 v4, s[40:43], s60 offen offset:2048 lds
    buffer_load_dwordx4 v5, s[40:43], s60 offen offset:3072 lds
    s_add_u32 m0, s57, 57344
    s_mov_b32 s61, 737280
    buffer_load_dwordx4 v6, s[44:47], s61 offen offset:0 lds
    buffer_load_dwordx4 v7, s[44:47], s61 offen offset:1024 lds
    s_add_u32 m0, s58, 102464
    s_mov_b32 s62, 589824
    buffer_load_dwordx4 v8, s[48:51], s62 offen offset:0 lds
    buffer_load_dwordx4 v9, s[48:51], s62 offen offset:1024 lds
    buffer_load_dwordx4 v13, s[48:51], s62 offen offset:2048 lds
    v_mfma_f32_16x16x32_bf16 v[144:147], v[160:163], v[112:115], v[144:147]
    v_mfma_f32_16x16x32_bf16 v[152:155], v[112:115], v[112:115], v[152:155]
    v_mfma_f32_16x16x32_bf16 v[148:151], v[160:163], v[120:123], v[148:151]
    v_mfma_f32_16x16x32_bf16 v[156:159], v[120:123], v[120:123], v[156:159]
    v_mfma_f32_16x16x32_bf16 v[144:147], v[160:163], v[116:119], v[144:147]
    v_mfma_f32_16x16x32_bf16 v[152:155], v[116:119], v[116:119], v[152:155]
    v_mfma_f32_16x16x32_bf16 v[148:151], v[160:163], v[124:127], v[148:151]
    v_mfma_f32_16x16x32_bf16 v[156:159], v[124:127], v[124:127], v[156:159]
    s_waitcnt vmcnt(9)
    v_mov_b32 v22, 6
    ds_write_b32 v21, v22
    s_waitcnt lgkmcnt(0)
    v_mul_u32_u24 v24, 3, v25
    v_mad_u32_u24 v24, v26, 3, v24
    v_cmp_gt_u32 vcc, v24, v23
    s_cbranch_vccnz L_PF7_S
L_PF7_ok:
    ds_read_b32 v23, v20
    s_add_u32 m0, s57, 65536
    s_mov_b32 s61, 860160
    buffer_load_dwordx4 v6, s[44:47], s61 offen offset:0 lds
    buffer_load_dwordx4 v7, s[44:47], s61 offen offset:1024 lds
    s_add_u32 m0, s58, 114816
    s_mov_b32 s62, 688128
    buffer_load_dwordx4 v8, s[48:51], s62 offen offset:0 lds
    buffer_load_dwordx4 v9, s[48:51], s62 offen offset:1024 lds
    buffer_load_dwordx4 v13, s[48:51], s62 offen offset:2048 lds
    s_waitcnt vmcnt(5)
    v_mov_b32 v22, 7
    ds_write_b32 v21, v22
    ds_read_b128 v[128:131], v164 offset:0
    ds_read_b128 v[132:135], v165 offset:0
    ds_read_b128 v[136:139], v164 offset:2048
    ds_read_b128 v[140:143], v165 offset:2048
    s_waitcnt lgkmcnt(0)
    v_mul_u32_u24 v24, 4, v25
    v_mad_u32_u24 v24, v26, 4, v24
    v_cmp_gt_u32 vcc, v24, v23
    s_cbranch_vccnz L_PF8_S
L_PF8_ok:
    ds_read_b32 v23, v20
    s_add_u32 m0, s56, 16384
    s_mov_b32 s60, 512
    buffer_load_dwordx4 v2, s[40:43], s60 offen offset:0 lds
    buffer_load_dwordx4 v3, s[40:43], s60 offen offset:1024 lds
    buffer_load_dwordx4 v4, s[40:43], s60 offen offset:2048 lds
    buffer_load_dwordx4 v5, s[40:43], s60 offen offset:3072 lds
    s_add_u32 m0, s57, 73728
    s_mov_b32 s61, 983040
    buffer_load_dwordx4 v6, s[44:47], s61 offen offset:0 lds
    buffer_load_dwordx4 v7, s[44:47], s61 offen offset:1024 lds
    s_add_u32 m0, s58, 127168
    s_mov_b32 s62, 786432
    buffer_load_dwordx4 v8, s[48:51], s62 offen offset:0 lds
    buffer_load_dwordx4 v9, s[48:51], s62 offen offset:1024 lds
    buffer_load_dwordx4 v13, s[48:51], s62 offen offset:2048 lds
    v_mfma_f32_16x16x32_bf16 v[144:147], v[160:163], v[128:131], v[144:147]
    v_mfma_f32_16x16x32_bf16 v[152:155], v[128:131], v[128:131], v[152:155]
    v_mfma_f32_16x16x32_bf16 v[148:151], v[160:163], v[136:139], v[148:151]
    v_mfma_f32_16x16x32_bf16 v[156:159], v[136:139], v[136:139], v[156:159]
    v_mfma_f32_16x16x32_bf16 v[144:147], v[160:163], v[132:135], v[144:147]
    v_mfma_f32_16x16x32_bf16 v[152:155], v[132:135], v[132:135], v[152:155]
    v_mfma_f32_16x16x32_bf16 v[148:151], v[160:163], v[140:143], v[148:151]
    v_mfma_f32_16x16x32_bf16 v[156:159], v[140:143], v[140:143], v[156:159]
    s_waitcnt vmcnt(9)
    v_mov_b32 v22, 8
    ds_write_b32 v21, v22
    s_waitcnt lgkmcnt(0)
    v_mul_u32_u24 v24, 5, v25
    v_mad_u32_u24 v24, v26, 5, v24
    v_cmp_gt_u32 vcc, v24, v23
    s_cbranch_vccnz L_PF9_S
L_PF9_ok:
    ds_read_b32 v23, v20
    s_add_u32 m0, s57, 81920
    s_mov_b32 s61, 1105920
    buffer_load_dwordx4 v6, s[44:47], s61 offen offset:0 lds
    buffer_load_dwordx4 v7, s[44:47], s61 offen offset:1024 lds
    s_add_u32 m0, s58, 139520
    s_mov_b32 s62, 884736
    buffer_load_dwordx4 v8, s[48:51], s62 offen offset:0 lds
    buffer_load_dwordx4 v9, s[48:51], s62 offen offset:1024 lds
    buffer_load_dwordx4 v13, s[48:51], s62 offen offset:2048 lds
    s_waitcnt vmcnt(5)
    v_mov_b32 v22, 9
    ds_write_b32 v21, v22
    ds_read_b128 v[112:115], v164 offset:16384
    ds_read_b128 v[116:119], v165 offset:16384
    ds_read_b128 v[120:123], v164 offset:18432
    ds_read_b128 v[124:127], v165 offset:18432
    s_waitcnt lgkmcnt(0)
    v_mul_u32_u24 v24, 6, v25
    v_mad_u32_u24 v24, v26, 6, v24
    v_cmp_gt_u32 vcc, v24, v23
    s_cbranch_vccnz L_PF10_S
L_PF10_ok:
    ds_read_b32 v23, v20
    s_add_u32 m0, s56, 32768
    s_mov_b32 s60, 640
    buffer_load_dwordx4 v2, s[40:43], s60 offen offset:0 lds
    buffer_load_dwordx4 v3, s[40:43], s60 offen offset:1024 lds
    buffer_load_dwordx4 v4, s[40:43], s60 offen offset:2048 lds
    buffer_load_dwordx4 v5, s[40:43], s60 offen offset:3072 lds
    s_add_u32 m0, s57, 49152
    s_mov_b32 s61, 1228800
    buffer_load_dwordx4 v6, s[44:47], s61 offen offset:0 lds
    buffer_load_dwordx4 v7, s[44:47], s61 offen offset:1024 lds
    s_add_u32 m0, s58, 90112
    s_mov_b32 s62, 983040
    buffer_load_dwordx4 v8, s[48:51], s62 offen offset:0 lds
    buffer_load_dwordx4 v9, s[48:51], s62 offen offset:1024 lds
    buffer_load_dwordx4 v13, s[48:51], s62 offen offset:2048 lds
    v_mfma_f32_16x16x32_bf16 v[144:147], v[160:163], v[112:115], v[144:147]
    v_mfma_f32_16x16x32_bf16 v[152:155], v[112:115], v[112:115], v[152:155]
    v_mfma_f32_16x16x32_bf16 v[148:151], v[160:163], v[120:123], v[148:151]
    v_mfma_f32_16x16x32_bf16 v[156:159], v[120:123], v[120:123], v[156:159]
    v_mfma_f32_16x16x32_bf16 v[144:147], v[160:163], v[116:119], v[144:147]
    v_mfma_f32_16x16x32_bf16 v[152:155], v[116:119], v[116:119], v[152:155]
    v_mfma_f32_16x16x32_bf16 v[148:151], v[160:163], v[124:127], v[148:151]
    v_mfma_f32_16x16x32_bf16 v[156:159], v[124:127], v[124:127], v[156:159]
    s_waitcnt vmcnt(9)
    v_mov_b32 v22, 10
    ds_write_b32 v21, v22
    s_waitcnt lgkmcnt(0)
    v_mul_u32_u24 v24, 7, v25
    v_mad_u32_u24 v24, v26, 7, v24
    v_cmp_gt_u32 vcc, v24, v23
    s_cbranch_vccnz L_PF11_S
L_PF11_ok:
    ds_read_b32 v23, v20
    s_add_u32 m0, s57, 57344
    s_mov_b32 s61, 1351680
    buffer_load_dwordx4 v6, s[44:47], s61 offen offset:0 lds
    buffer_load_dwordx4 v7, s[44:47], s61 offen offset:1024 lds
    s_add_u32 m0, s58, 102464
    s_mov_b32 s62, 1081344
    buffer_load_dwordx4 v8, s[48:51], s62 offen offset:0 lds
    buffer_load_dwordx4 v9, s[48:51], s62 offen offset:1024 lds
    buffer_load_dwordx4 v13, s[48:51], s62 offen offset:2048 lds
    s_waitcnt vmcnt(5)
    v_mov_b32 v22, 11
    ds_write_b32 v21, v22
    ds_read_b128 v[128:131], v164 offset:32768
    ds_read_b128 v[132:135], v165 offset:32768
    ds_read_b128 v[136:139], v164 offset:34816
    ds_read_b128 v[140:143], v165 offset:34816
    s_waitcnt lgkmcnt(0)
    v_mul_u32_u24 v24, 8, v25
    v_mad_u32_u24 v24, v26, 8, v24
    v_cmp_gt_u32 vcc, v24, v23
    s_cbranch_vccnz L_PF12_S
L_PF12_ok:
    ds_read_b32 v23, v20
    s_add_u32 m0, s56, 0
    s_mov_b32 s60, 768
    buffer_load_dwordx4 v2, s[40:43], s60 offen offset:0 lds
    buffer_load_dwordx4 v3, s[40:43], s60 offen offset:1024 lds
    buffer_load_dwordx4 v4, s[40:43], s60 offen offset:2048 lds
    buffer_load_dwordx4 v5, s[40:43], s60 offen offset:3072 lds
    s_add_u32 m0, s57, 65536
    s_mov_b32 s61, 1474560
    buffer_load_dwordx4 v6, s[44:47], s61 offen offset:0 lds
    buffer_load_dwordx4 v7, s[44:47], s61 offen offset:1024 lds
    s_add_u32 m0, s58, 114816
    s_mov_b32 s62, 1179648
    buffer_load_dwordx4 v8, s[48:51], s62 offen offset:0 lds
    buffer_load_dwordx4 v9, s[48:51], s62 offen offset:1024 lds
    buffer_load_dwordx4 v13, s[48:51], s62 offen offset:2048 lds
    v_mfma_f32_16x16x32_bf16 v[144:147], v[160:163], v[128:131], v[144:147]
    v_mfma_f32_16x16x32_bf16 v[152:155], v[128:131], v[128:131], v[152:155]
    v_mfma_f32_16x16x32_bf16 v[148:151], v[160:163], v[136:139], v[148:151]
    v_mfma_f32_16x16x32_bf16 v[156:159], v[136:139], v[136:139], v[156:159]
    v_mfma_f32_16x16x32_bf16 v[144:147], v[160:163], v[132:135], v[144:147]
    v_mfma_f32_16x16x32_bf16 v[152:155], v[132:135], v[132:135], v[152:155]
    v_mfma_f32_16x16x32_bf16 v[148:151], v[160:163], v[140:143], v[148:151]
    v_mfma_f32_16x16x32_bf16 v[156:159], v[140:143], v[140:143], v[156:159]
    s_waitcnt vmcnt(9)
    v_mov_b32 v22, 12
    ds_write_b32 v21, v22
    s_waitcnt lgkmcnt(0)
    v_mul_u32_u24 v24, 9, v25
    v_mad_u32_u24 v24, v26, 9, v24
    v_cmp_gt_u32 vcc, v24, v23
    s_cbranch_vccnz L_PF13_S
L_PF13_ok:
    ds_read_b32 v23, v20
    s_add_u32 m0, s57, 73728
    s_mov_b32 s61, 1597440
    buffer_load_dwordx4 v6, s[44:47], s61 offen offset:0 lds
    buffer_load_dwordx4 v7, s[44:47], s61 offen offset:1024 lds
    s_add_u32 m0, s58, 127168
    s_mov_b32 s62, 1277952
    buffer_load_dwordx4 v8, s[48:51], s62 offen offset:0 lds
    buffer_load_dwordx4 v9, s[48:51], s62 offen offset:1024 lds
    buffer_load_dwordx4 v13, s[48:51], s62 offen offset:2048 lds
    s_waitcnt vmcnt(5)
    v_mov_b32 v22, 13
    ds_write_b32 v21, v22
    ds_read_b128 v[112:115], v164 offset:0
    ds_read_b128 v[116:119], v165 offset:0
    ds_read_b128 v[120:123], v164 offset:2048
    ds_read_b128 v[124:127], v165 offset:2048
    s_waitcnt lgkmcnt(0)
    v_mul_u32_u24 v24, 10, v25
    v_mad_u32_u24 v24, v26, 10, v24
    v_cmp_gt_u32 vcc, v24, v23
    s_cbranch_vccnz L_PF14_S
L_PF14_ok:
    ds_read_b32 v23, v20
    s_add_u32 m0, s56, 16384
    s_mov_b32 s60, 896
    buffer_load_dwordx4 v2, s[40:43], s60 offen offset:0 lds
    buffer_load_dwordx4 v3, s[40:43], s60 offen offset:1024 lds
    buffer_load_dwordx4 v4, s[40:43], s60 offen offset:2048 lds
    buffer_load_dwordx4 v5, s[40:43], s60 offen offset:3072 lds
    s_add_u32 m0, s57, 81920
    s_mov_b32 s61, 1720320
    buffer_load_dwordx4 v6, s[44:47], s61 offen offset:0 lds
    buffer_load_dwordx4 v7, s[44:47], s61 offen offset:1024 lds
    s_add_u32 m0, s58, 139520
    s_mov_b32 s62, 1376256
    buffer_load_dwordx4 v8, s[48:51], s62 offen offset:0 lds
    buffer_load_dwordx4 v9, s[48:51], s62 offen offset:1024 lds
    buffer_load_dwordx4 v13, s[48:51], s62 offen offset:2048 lds
    v_mfma_f32_16x16x32_bf16 v[144:147], v[160:163], v[112:115], v[144:147]
    v_mfma_f32_16x16x32_bf16 v[152:155], v[112:115], v[112:115], v[152:155]
    v_mfma_f32_16x16x32_bf16 v[148:151], v[160:163], v[120:123], v[148:151]
    v_mfma_f32_16x16x32_bf16 v[156:159], v[120:123], v[120:123], v[156:159]
    v_mfma_f32_16x16x32_bf16 v[144:147], v[160:163], v[116:119], v[144:147]
    v_mfma_f32_16x16x32_bf16 v[152:155], v[116:119], v[116:119], v[152:155]
    v_mfma_f32_16x16x32_bf16 v[148:151], v[160:163], v[124:127], v[148:151]
    v_mfma_f32_16x16x32_bf16 v[156:159], v[124:127], v[124:127], v[156:159]
    s_waitcnt vmcnt(9)
    v_mov_b32 v22, 14
    ds_write_b32 v21, v22
    s_waitcnt lgkmcnt(0)
    v_mul_u32_u24 v24, 11, v25
    v_mad_u32_u24 v24, v26, 11, v24
    v_cmp_gt_u32 vcc, v24, v23
    s_cbranch_vccnz L_PF15_S
L_PF15_ok:
    ds_read_b32 v23, v20
    s_add_u32 m0, s57, 49152
    s_mov_b32 s61, 1843200
    buffer_load_dwordx4 v6, s[44:47], s61 offen offset:0 lds
    buffer_load_dwordx4 v7, s[44:47], s61 offen offset:1024 lds
    s_add_u32 m0, s58, 90112
    s_mov_b32 s62, 1474560
    buffer_load_dwordx4 v8, s[48:51], s62 offen offset:0 lds
    buffer_load_dwordx4 v9, s[48:51], s62 offen offset:1024 lds
    buffer_load_dwordx4 v13, s[48:51], s62 offen offset:2048 lds
    s_waitcnt vmcnt(5)
    v_mov_b32 v22, 15
    ds_write_b32 v21, v22
    ds_read_b128 v[128:131], v164 offset:16384
    ds_read_b128 v[132:135], v165 offset:16384
    ds_read_b128 v[136:139], v164 offset:18432
    ds_read_b128 v[140:143], v165 offset:18432
    s_waitcnt lgkmcnt(0)
    v_mul_u32_u24 v24, 12, v25
    v_mad_u32_u24 v24, v26, 12, v24
    v_cmp_gt_u32 vcc, v24, v23
    s_cbranch_vccnz L_PF16_S
L_PF16_ok:
    ds_read_b32 v23, v20
    s_add_u32 m0, s56, 32768
    s_mov_b32 s60, 1024
    buffer_load_dwordx4 v2, s[40:43], s60 offen offset:0 lds
    buffer_load_dwordx4 v3, s[40:43], s60 offen offset:1024 lds
    buffer_load_dwordx4 v4, s[40:43], s60 offen offset:2048 lds
    buffer_load_dwordx4 v5, s[40:43], s60 offen offset:3072 lds
    s_add_u32 m0, s57, 57344
    s_mov_b32 s61, 1966080
    buffer_load_dwordx4 v6, s[44:47], s61 offen offset:0 lds
    buffer_load_dwordx4 v7, s[44:47], s61 offen offset:1024 lds
    s_add_u32 m0, s58, 102464
    s_mov_b32 s62, 1572864
    buffer_load_dwordx4 v8, s[48:51], s62 offen offset:0 lds
    buffer_load_dwordx4 v9, s[48:51], s62 offen offset:1024 lds
    buffer_load_dwordx4 v13, s[48:51], s62 offen offset:2048 lds
    v_mfma_f32_16x16x32_bf16 v[144:147], v[160:163], v[128:131], v[144:147]
    v_mfma_f32_16x16x32_bf16 v[152:155], v[128:131], v[128:131], v[152:155]
    v_mfma_f32_16x16x32_bf16 v[148:151], v[160:163], v[136:139], v[148:151]
    v_mfma_f32_16x16x32_bf16 v[156:159], v[136:139], v[136:139], v[156:159]
    v_mfma_f32_16x16x32_bf16 v[144:147], v[160:163], v[132:135], v[144:147]
    v_mfma_f32_16x16x32_bf16 v[152:155], v[132:135], v[132:135], v[152:155]
    v_mfma_f32_16x16x32_bf16 v[148:151], v[160:163], v[140:143], v[148:151]
    v_mfma_f32_16x16x32_bf16 v[156:159], v[140:143], v[140:143], v[156:159]
    s_waitcnt vmcnt(9)
    v_mov_b32 v22, 16
    ds_write_b32 v21, v22
    s_waitcnt lgkmcnt(0)
    v_mul_u32_u24 v24, 13, v25
    v_mad_u32_u24 v24, v26, 13, v24
    v_cmp_gt_u32 vcc, v24, v23
    s_cbranch_vccnz L_PF17_S
L_PF17_ok:
    ds_read_b32 v23, v20
    s_add_u32 m0, s57, 65536
    s_mov_b32 s61, 2088960
    buffer_load_dwordx4 v6, s[44:47], s61 offen offset:0 lds
    buffer_load_dwordx4 v7, s[44:47], s61 offen offset:1024 lds
    s_add_u32 m0, s58, 114816
    s_mov_b32 s62, 1671168
    buffer_load_dwordx4 v8, s[48:51], s62 offen offset:0 lds
    buffer_load_dwordx4 v9, s[48:51], s62 offen offset:1024 lds
    buffer_load_dwordx4 v13, s[48:51], s62 offen offset:2048 lds
    s_waitcnt vmcnt(5)
    v_mov_b32 v22, 17
    ds_write_b32 v21, v22
    ds_read_b128 v[112:115], v164 offset:32768
    ds_read_b128 v[116:119], v165 offset:32768
    ds_read_b128 v[120:123], v164 offset:34816
    ds_read_b128 v[124:127], v165 offset:34816
    s_waitcnt lgkmcnt(0)
    v_mul_u32_u24 v24, 14, v25
    v_mad_u32_u24 v24, v26, 14, v24
    v_cmp_gt_u32 vcc, v24, v23
    s_cbranch_vccnz L_PF18_S
L_PF18_ok:
    ds_read_b32 v23, v20
    s_add_u32 m0, s56, 0
    s_mov_b32 s60, 1152
    buffer_load_dwordx4 v2, s[40:43], s60 offen offset:0 lds
    buffer_load_dwordx4 v3, s[40:43], s60 offen offset:1024 lds
    buffer_load_dwordx4 v4, s[40:43], s60 offen offset:2048 lds
    buffer_load_dwordx4 v5, s[40:43], s60 offen offset:3072 lds
    s_add_u32 m0, s57, 73728
    s_mov_b32 s61, 2211840
    buffer_load_dwordx4 v6, s[44:47], s61 offen offset:0 lds
    buffer_load_dwordx4 v7, s[44:47], s61 offen offset:1024 lds
    s_add_u32 m0, s58, 127168
    s_mov_b32 s62, 1769472
    buffer_load_dwordx4 v8, s[48:51], s62 offen offset:0 lds
    buffer_load_dwordx4 v9, s[48:51], s62 offen offset:1024 lds
    buffer_load_dwordx4 v13, s[48:51], s62 offen offset:2048 lds
    v_mfma_f32_16x16x32_bf16 v[144:147], v[160:163], v[112:115], v[144:147]
    v_mfma_f32_16x16x32_bf16 v[152:155], v[112:115], v[112:115], v[152:155]
    v_mfma_f32_16x16x32_bf16 v[148:151], v[160:163], v[120:123], v[148:151]
    v_mfma_f32_16x16x32_bf16 v[156:159], v[120:123], v[120:123], v[156:159]
    v_mfma_f32_16x16x32_bf16 v[144:147], v[160:163], v[116:119], v[144:147]
    v_mfma_f32_16x16x32_bf16 v[152:155], v[116:119], v[116:119], v[152:155]
    v_mfma_f32_16x16x32_bf16 v[148:151], v[160:163], v[124:127], v[148:151]
    v_mfma_f32_16x16x32_bf16 v[156:159], v[124:127], v[124:127], v[156:159]
    s_waitcnt vmcnt(9)
    v_mov_b32 v22, 18
    ds_write_b32 v21, v22
    s_waitcnt lgkmcnt(0)
    v_mul_u32_u24 v24, 15, v25
    v_mad_u32_u24 v24, v26, 15, v24
    v_cmp_gt_u32 vcc, v24, v23
    s_cbranch_vccnz L_PF19_S
L_PF19_ok:
    ds_read_b32 v23, v20
    s_add_u32 m0, s57, 81920
    s_mov_b32 s61, 2334720
    buffer_load_dwordx4 v6, s[44:47], s61 offen offset:0 lds
    buffer_load_dwordx4 v7, s[44:47], s61 offen offset:1024 lds
    s_add_u32 m0, s58, 139520
    s_mov_b32 s62, 1867776
    buffer_load_dwordx4 v8, s[48:51], s62 offen offset:0 lds
    buffer_load_dwordx4 v9, s[48:51], s62 offen offset:1024 lds
    buffer_load_dwordx4 v13, s[48:51], s62 offen offset:2048 lds
    s_waitcnt vmcnt(5)
    v_mov_b32 v22, 19
    ds_write_b32 v21, v22
    ds_read_b128 v[128:131], v164 offset:0
    ds_read_b128 v[132:135], v165 offset:0
    ds_read_b128 v[136:139], v164 offset:2048
    ds_read_b128 v[140:143], v165 offset:2048
    s_waitcnt lgkmcnt(0)
    v_mul_u32_u24 v24, 16, v25
    v_mad_u32_u24 v24, v26, 16, v24
    v_cmp_gt_u32 vcc, v24, v23
    s_cbranch_vccnz L_PFR_S
L_PFR_ok:
    ds_read_b32 v23, v20
    v_mfma_f32_16x16x32_bf16 v[144:147], v[160:163], v[128:131], v[144:147]
    v_mfma_f32_16x16x32_bf16 v[152:155], v[128:131], v[128:131], v[152:155]
    v_mfma_f32_16x16x32_bf16 v[148:151], v[160:163], v[136:139], v[148:151]
    v_mfma_f32_16x16x32_bf16 v[156:159], v[136:139], v[136:139], v[156:159]
    v_mfma_f32_16x16x32_bf16 v[144:147], v[160:163], v[132:135], v[144:147]
    v_mfma_f32_16x16x32_bf16 v[152:155], v[132:135], v[132:135], v[152:155]
    v_mfma_f32_16x16x32_bf16 v[148:151], v[160:163], v[140:143], v[148:151]
    v_mfma_f32_16x16x32_bf16 v[156:159], v[140:143], v[140:143], v[156:159]
    s_lshl_b32 s52, s28, 8
    s_add_u32 s52, s52, s2
    s_cmp_lt_u32 s52, 544
    s_cbranch_scc0 L_P_NOREP
    s_mul_i32 s53, s52, 964
    s_lshr_b32 s53, s53, 16
    s_mul_i32 s54, s53, 68
    s_sub_u32 s54, s52, s54
    s_mov_b32 s67, s53
    s_mov_b32 s68, s54
    s_cmp_lt_u32 s54, 48
    s_cselect_b32 s48, s16, s8
    s_cselect_b32 s49, s17, s9
    s_mov_b32 s50, 819200
    s_cselect_b32 s50, 1966080, s50
    s_and_b32 s49, s49, 0xffff
    s_mov_b32 s51, 0x00020000
    s_mul_i32 s55, s53, 160
    s_mul_i32 s56, s28, 5120
    s_add_u32 s56, s56, 16384
    v_add_u32 v12, 0, v0
    v_mul_u32_u24 v13, 6554, v12
    v_lshrrev_b32 v13, 16, v13
    v_mul_u32_u24 v14, 10, v13
    v_sub_u32 v12, v12, v14
    v_lshrrev_b32 v14, 3, v13
    v_bfe_u32 v15, v13, 2, 1
    v_and_b32 v13, 3, v13
    s_cmp_lt_u32 s54, 48
    s_cbranch_scc0 L_P_WO0
    v_lshrrev_b32 v60, 1, v14
    v_lshlrev_b32 v60, 4, v60
    v_and_b32 v61, 1, v14
    v_lshl_add_u32 v60, v61, 2, v60
    v_lshl_add_u32 v60, v15, 3, v60
    s_lshl_b32 s57, s54, 5
    v_add_u32 v60, s57, v60
    s_branch L_P_WD0
L_P_WO0:
    s_sub_u32 s57, s54, 48
    s_lshl_b32 s57, s57, 2
    v_add_u32 v60, s57, v14
    v_mul_u32_u24 v61, 205, v60
    v_lshrrev_b32 v61, 10, v61
    v_mul_u32_u24 v62, 5, v61
    v_sub_u32 v62, v60, v62
    v_mul_u32_u24 v60, 40, v61
    v_lshlrev_b32 v61, 3, v15
    v_mul_u32_u24 v63, 20, v15
    v_lshlrev_b32 v64, 2, v62
    v_add_u32 v64, 8, v64
    v_add_u32 v65, v64, v61
    v_cmp_eq_u32 vcc, 0, v62
    v_cndmask_b32 v65, v65, v61, vcc
    v_add_u32 v64, 4, v61
    v_cmp_eq_u32 vcc, 1, v62
    v_cndmask_b32 v65, v65, v64, vcc
    v_add_u32 v64, 16, v63
    v_cmp_eq_u32 vcc, 2, v62
    v_cndmask_b32 v65, v65, v64, vcc
    v_add_u32 v60, v60, v65
L_P_WD0:
    v_add_u32 v60, v60, v13
    v_mul_u32_u24 v60, 1280, v60
    v_lshl_add_u32 v60, v12, 4, v60
    s_add_u32 m0, s56, 0
    v_add_u32 v60, s55, v60
    buffer_load_dwordx4 v60, s[48:51], 0 offen lds
    v_add_u32 v12, 64, v0
    v_mul_u32_u24 v13, 6554, v12
    v_lshrrev_b32 v13, 16, v13
    v_mul_u32_u24 v14, 10, v13
    v_sub_u32 v12, v12, v14
    v_lshrrev_b32 v14, 3, v13
    v_bfe_u32 v15, v13, 2, 1
    v_and_b32 v13, 3, v13
    s_cmp_lt_u32 s54, 48
    s_cbranch_scc0 L_P_WO1
    v_lshrrev_b32 v60, 1, v14
    v_lshlrev_b32 v60, 4, v60
    v_and_b32 v61, 1, v14
    v_lshl_add_u32 v60, v61, 2, v60
    v_lshl_add_u32 v60, v15, 3, v60
    s_lshl_b32 s57, s54, 5
    v_add_u32 v60, s57, v60
    s_branch L_P_WD1
L_P_WO1:
    s_sub_u32 s57, s54, 48
    s_lshl_b32 s57, s57, 2
    v_add_u32 v60, s57, v14
    v_mul_u32_u24 v61, 205, v60
    v_lshrrev_b32 v61, 10, v61
    v_mul_u32_u24 v62, 5, v61
    v_sub_u32 v62, v60, v62
    v_mul_u32_u24 v60, 40, v61
    v_lshlrev_b32 v61, 3, v15
    v_mul_u32_u24 v63, 20, v15
    v_lshlrev_b32 v64, 2, v62
    v_add_u32 v64, 8, v64
    v_add_u32 v65, v64, v61
    v_cmp_eq_u32 vcc, 0, v62
    v_cndmask_b32 v65, v65, v61, vcc
    v_add_u32 v64, 4, v61
    v_cmp_eq_u32 vcc, 1, v62
    v_cndmask_b32 v65, v65, v64, vcc
    v_add_u32 v64, 16, v63
    v_cmp_eq_u32 vcc, 2, v62
    v_cndmask_b32 v65, v65, v64, vcc
    v_add_u32 v60, v60, v65
L_P_WD1:
    v_add_u32 v60, v60, v13
    v_mul_u32_u24 v60, 1280, v60
    v_lshl_add_u32 v60, v12, 4, v60
    s_add_u32 m0, s56, 1024
    v_add_u32 v60, s55, v60
    buffer_load_dwordx4 v60, s[48:51], 0 offen lds
    v_add_u32 v12, 128, v0
    v_mul_u32_u24 v13, 6554, v12
    v_lshrrev_b32 v13, 16, v13
    v_mul_u32_u24 v14, 10, v13
    v_sub_u32 v12, v12, v14
    v_lshrrev_b32 v14, 3, v13
    v_bfe_u32 v15, v13, 2, 1
    v_and_b32 v13, 3, v13
    s_cmp_lt_u32 s54, 48
    s_cbranch_scc0 L_P_WO2
    v_lshrrev_b32 v60, 1, v14
    v_lshlrev_b32 v60, 4, v60
    v_and_b32 v61, 1, v14
    v_lshl_add_u32 v60, v61, 2, v60
    v_lshl_add_u32 v60, v15, 3, v60
    s_lshl_b32 s57, s54, 5
    v_add_u32 v60, s57, v60
    s_branch L_P_WD2
L_P_WO2:
    s_sub_u32 s57, s54, 48
    s_lshl_b32 s57, s57, 2
    v_add_u32 v60, s57, v14
    v_mul_u32_u24 v61, 205, v60
    v_lshrrev_b32 v61, 10, v61
    v_mul_u32_u24 v62, 5, v61
    v_sub_u32 v62, v60, v62
    v_mul_u32_u24 v60, 40, v61
    v_lshlrev_b32 v61, 3, v15
    v_mul_u32_u24 v63, 20, v15
    v_lshlrev_b32 v64, 2, v62
    v_add_u32 v64, 8, v64
    v_add_u32 v65, v64, v61
    v_cmp_eq_u32 vcc, 0, v62
    v_cndmask_b32 v65, v65, v61, vcc
    v_add_u32 v64, 4, v61
    v_cmp_eq_u32 vcc, 1, v62
    v_cndmask_b32 v65, v65, v64, vcc
    v_add_u32 v64, 16, v63
    v_cmp_eq_u32 vcc, 2, v62
    v_cndmask_b32 v65, v65, v64, vcc
    v_add_u32 v60, v60, v65
L_P_WD2:
    v_add_u32 v60, v60, v13
    v_mul_u32_u24 v60, 1280, v60
    v_lshl_add_u32 v60, v12, 4, v60
    s_add_u32 m0, s56, 2048
    v_add_u32 v60, s55, v60
    buffer_load_dwordx4 v60, s[48:51], 0 offen lds
    v_add_u32 v12, 192, v0
    v_mul_u32_u24 v13, 6554, v12
    v_lshrrev_b32 v13, 16, v13
    v_mul_u32_u24 v14, 10, v13
    v_sub_u32 v12, v12, v14
    v_lshrrev_b32 v14, 3, v13
    v_bfe_u32 v15, v13, 2, 1
    v_and_b32 v13, 3, v13
    s_cmp_lt_u32 s54, 48
    s_cbranch_scc0 L_P_WO3
    v_lshrrev_b32 v60, 1, v14
    v_lshlrev_b32 v60, 4, v60
    v_and_b32 v61, 1, v14
    v_lshl_add_u32 v60, v61, 2, v60
    v_lshl_add_u32 v60, v15, 3, v60
    s_lshl_b32 s57, s54, 5
    v_add_u32 v60, s57, v60
    s_branch L_P_WD3
L_P_WO3:
    s_sub_u32 s57, s54, 48
    s_lshl_b32 s57, s57, 2
    v_add_u32 v60, s57, v14
    v_mul_u32_u24 v61, 205, v60
    v_lshrrev_b32 v61, 10, v61
    v_mul_u32_u24 v62, 5, v61
    v_sub_u32 v62, v60, v62
    v_mul_u32_u24 v60, 40, v61
    v_lshlrev_b32 v61, 3, v15
    v_mul_u32_u24 v63, 20, v15
    v_lshlrev_b32 v64, 2, v62
    v_add_u32 v64, 8, v64
    v_add_u32 v65, v64, v61
    v_cmp_eq_u32 vcc, 0, v62
    v_cndmask_b32 v65, v65, v61, vcc
    v_add_u32 v64, 4, v61
    v_cmp_eq_u32 vcc, 1, v62
    v_cndmask_b32 v65, v65, v64, vcc
    v_add_u32 v64, 16, v63
    v_cmp_eq_u32 vcc, 2, v62
    v_cndmask_b32 v65, v65, v64, vcc
    v_add_u32 v60, v60, v65
L_P_WD3:
    v_add_u32 v60, v60, v13
    v_mul_u32_u24 v60, 1280, v60
    v_lshl_add_u32 v60, v12, 4, v60
    s_add_u32 m0, s56, 3072
    v_add_u32 v60, s55, v60
    buffer_load_dwordx4 v60, s[48:51], 0 offen lds
    v_add_u32 v12, 256, v0
    v_mul_u32_u24 v13, 6554, v12
    v_lshrrev_b32 v13, 16, v13
    v_mul_u32_u24 v14, 10, v13
    v_sub_u32 v12, v12, v14
    v_lshrrev_b32 v14, 3, v13
    v_bfe_u32 v15, v13, 2, 1
    v_and_b32 v13, 3, v13
    s_cmp_lt_u32 s54, 48
    s_cbranch_scc0 L_P_WO4
    v_lshrrev_b32 v60, 1, v14
    v_lshlrev_b32 v60, 4, v60
    v_and_b32 v61, 1, v14
    v_lshl_add_u32 v60, v61, 2, v60
    v_lshl_add_u32 v60, v15, 3, v60
    s_lshl_b32 s57, s54, 5
    v_add_u32 v60, s57, v60
    s_branch L_P_WD4
L_P_WO4:
    s_sub_u32 s57, s54, 48
    s_lshl_b32 s57, s57, 2
    v_add_u32 v60, s57, v14
    v_mul_u32_u24 v61, 205, v60
    v_lshrrev_b32 v61, 10, v61
    v_mul_u32_u24 v62, 5, v61
    v_sub_u32 v62, v60, v62
    v_mul_u32_u24 v60, 40, v61
    v_lshlrev_b32 v61, 3, v15
    v_mul_u32_u24 v63, 20, v15
    v_lshlrev_b32 v64, 2, v62
    v_add_u32 v64, 8, v64
    v_add_u32 v65, v64, v61
    v_cmp_eq_u32 vcc, 0, v62
    v_cndmask_b32 v65, v65, v61, vcc
    v_add_u32 v64, 4, v61
    v_cmp_eq_u32 vcc, 1, v62
    v_cndmask_b32 v65, v65, v64, vcc
    v_add_u32 v64, 16, v63
    v_cmp_eq_u32 vcc, 2, v62
    v_cndmask_b32 v65, v65, v64, vcc
    v_add_u32 v60, v60, v65
L_P_WD4:
    v_add_u32 v60, v60, v13
    v_mul_u32_u24 v60, 1280, v60
    v_lshl_add_u32 v60, v12, 4, v60
    s_add_u32 m0, s56, 4096
    v_add_u32 v60, s55, v60
    buffer_load_dwordx4 v60, s[48:51], 0 offen lds
    s_waitcnt vmcnt(5)
    v_mov_b32 v22, 20
    ds_write_b32 v21, v22
    s_waitcnt lgkmcnt(0)
    s_mov_b32 s69, 1
    s_branch L_P_STATS
L_P_NOREP:
    s_waitcnt vmcnt(0)
    v_mov_b32 v22, 20
    ds_write_b32 v21, v22
    s_waitcnt lgkmcnt(0)
    s_mov_b32 s69, 0
    s_branch L_P_STATS
L_PF5_S:
    s_mov_b32 s59, 0
L_PF5_L:
    ds_read_b32 v23, v20
    s_waitcnt lgkmcnt(0)
    v_cmp_gt_u32 vcc, v24, v23
    s_cbranch_vccz L_PF5_ok
    s_add_u32 s59, s59, 1
    s_cmp_lt_u32 s59, 200000
    s_cbranch_scc0 L_PF5_ok
    s_sleep 1
    s_branch L_PF5_L
L_PF6_S:
    s_mov_b32 s59, 0
L_PF6_L:
    ds_read_b32 v23, v20
    s_waitcnt lgkmcnt(0)
    v_cmp_gt_u32 vcc, v24, v23
    s_cbranch_vccz L_PF6_ok
    s_add_u32 s59, s59, 1
    s_cmp_lt_u32 s59, 200000
    s_cbranch_scc0 L_PF6_ok
    s_sleep 1
    s_branch L_PF6_L
L_PF7_S:
    s_mov_b32 s59, 0
L_PF7_L:
    ds_read_b32 v23, v20
    s_waitcnt lgkmcnt(0)
    v_cmp_gt_u32 vcc, v24, v23
    s_cbranch_vccz L_PF7_ok
    s_add_u32 s59, s59, 1
    s_cmp_lt_u32 s59, 200000
    s_cbranch_scc0 L_PF7_ok
    s_sleep 1
    s_branch L_PF7_L
L_PF8_S:
    s_mov_b32 s59, 0
L_PF8_L:
    ds_read_b32 v23, v20
    s_waitcnt lgkmcnt(0)
    v_cmp_gt_u32 vcc, v24, v23
    s_cbranch_vccz L_PF8_ok
    s_add_u32 s59, s59, 1
    s_cmp_lt_u32 s59, 200000
    s_cbranch_scc0 L_PF8_ok
    s_sleep 1
    s_branch L_PF8_L
L_PF9_S:
    s_mov_b32 s59, 0
L_PF9_L:
    ds_read_b32 v23, v20
    s_waitcnt lgkmcnt(0)
    v_cmp_gt_u32 vcc, v24, v23
    s_cbranch_vccz L_PF9_ok
    s_add_u32 s59, s59, 1
    s_cmp_lt_u32 s59, 200000
    s_cbranch_scc0 L_PF9_ok
    s_sleep 1
    s_branch L_PF9_L
L_PF10_S:
    s_mov_b32 s59, 0
L_PF10_L:
    ds_read_b32 v23, v20
    s_waitcnt lgkmcnt(0)
    v_cmp_gt_u32 vcc, v24, v23
    s_cbranch_vccz L_PF10_ok
    s_add_u32 s59, s59, 1
    s_cmp_lt_u32 s59, 200000
    s_cbranch_scc0 L_PF10_ok
    s_sleep 1
    s_branch L_PF10_L
L_PF11_S:
    s_mov_b32 s59, 0
L_PF11_L:
    ds_read_b32 v23, v20
    s_waitcnt lgkmcnt(0)
    v_cmp_gt_u32 vcc, v24, v23
    s_cbranch_vccz L_PF11_ok
    s_add_u32 s59, s59, 1
    s_cmp_lt_u32 s59, 200000
    s_cbranch_scc0 L_PF11_ok
    s_sleep 1
    s_branch L_PF11_L
L_PF12_S:
    s_mov_b32 s59, 0
L_PF12_L:
    ds_read_b32 v23, v20
    s_waitcnt lgkmcnt(0)
    v_cmp_gt_u32 vcc, v24, v23
    s_cbranch_vccz L_PF12_ok
    s_add_u32 s59, s59, 1
    s_cmp_lt_u32 s59, 200000
    s_cbranch_scc0 L_PF12_ok
    s_sleep 1
    s_branch L_PF12_L
L_PF13_S:
    s_mov_b32 s59, 0
L_PF13_L:
    ds_read_b32 v23, v20
    s_waitcnt lgkmcnt(0)
    v_cmp_gt_u32 vcc, v24, v23
    s_cbranch_vccz L_PF13_ok
    s_add_u32 s59, s59, 1
    s_cmp_lt_u32 s59, 200000
    s_cbranch_scc0 L_PF13_ok
    s_sleep 1
    s_branch L_PF13_L
L_PF14_S:
    s_mov_b32 s59, 0
L_PF14_L:
    ds_read_b32 v23, v20
    s_waitcnt lgkmcnt(0)
    v_cmp_gt_u32 vcc, v24, v23
    s_cbranch_vccz L_PF14_ok
    s_add_u32 s59, s59, 1
    s_cmp_lt_u32 s59, 200000
    s_cbranch_scc0 L_PF14_ok
    s_sleep 1
    s_branch L_PF14_L
L_PF15_S:
    s_mov_b32 s59, 0
L_PF15_L:
    ds_read_b32 v23, v20
    s_waitcnt lgkmcnt(0)
    v_cmp_gt_u32 vcc, v24, v23
    s_cbranch_vccz L_PF15_ok
    s_add_u32 s59, s59, 1
    s_cmp_lt_u32 s59, 200000
    s_cbranch_scc0 L_PF15_ok
    s_sleep 1
    s_branch L_PF15_L
L_PF16_S:
    s_mov_b32 s59, 0
L_PF16_L:
    ds_read_b32 v23, v20
    s_waitcnt lgkmcnt(0)
    v_cmp_gt_u32 vcc, v24, v23
    s_cbranch_vccz L_PF16_ok
    s_add_u32 s59, s59, 1
    s_cmp_lt_u32 s59, 200000
    s_cbranch_scc0 L_PF16_ok
    s_sleep 1
    s_branch L_PF16_L
L_PF17_S:
    s_mov_b32 s59, 0
L_PF17_L:
    ds_read_b32 v23, v20
    s_waitcnt lgkmcnt(0)
    v_cmp_gt_u32 vcc, v24, v23
    s_cbranch_vccz L_PF17_ok
    s_add_u32 s59, s59, 1
    s_cmp_lt_u32 s59, 200000
    s_cbranch_scc0 L_PF17_ok
    s_sleep 1
    s_branch L_PF17_L
L_PF18_S:
    s_mov_b32 s59, 0
L_PF18_L:
    ds_read_b32 v23, v20
    s_waitcnt lgkmcnt(0)
    v_cmp_gt_u32 vcc, v24, v23
    s_cbranch_vccz L_PF18_ok
    s_add_u32 s59, s59, 1
    s_cmp_lt_u32 s59, 200000
    s_cbranch_scc0 L_PF18_ok
    s_sleep 1
    s_branch L_PF18_L
L_PF19_S:
    s_mov_b32 s59, 0
L_PF19_L:
    ds_read_b32 v23, v20
    s_waitcnt lgkmcnt(0)
    v_cmp_gt_u32 vcc, v24, v23
    s_cbranch_vccz L_PF19_ok
    s_add_u32 s59, s59, 1
    s_cmp_lt_u32 s59, 200000
    s_cbranch_scc0 L_PF19_ok
    s_sleep 1
    s_branch L_PF19_L
L_PFR_S:
    s_mov_b32 s59, 0
L_PFR_L:
    ds_read_b32 v23, v20
    s_waitcnt lgkmcnt(0)
    v_cmp_gt_u32 vcc, v24, v23
    s_cbranch_vccz L_PFR_ok
    s_add_u32 s59, s59, 1
    s_cmp_lt_u32 s59, 200000
    s_cbranch_scc0 L_PFR_ok
    s_sleep 1
    s_branch L_PFR_L
L_P_STATS:
    s_nop 7
    v_and_b32 v112, 3, v0
    v_bfe_u32 v113, v0, 2, 2
    v_lshrrev_b32 v114, 4, v0
    v_cmp_eq_u32 s[52:53], v113, v114
    v_cmp_eq_u32 vcc, 1, v112
    v_cndmask_b32 v116, v152, v153, vcc
    v_cmp_eq_u32 vcc, 2, v112
    v_cndmask_b32 v116, v116, v154, vcc
    v_cmp_eq_u32 vcc, 3, v112
    v_cndmask_b32 v116, v116, v155, vcc
    v_cndmask_b32 v116, 0, v116, s[52:53]
    v_cmp_eq_u32 vcc, 1, v112
    v_cndmask_b32 v117, v156, v157, vcc
    v_cmp_eq_u32 vcc, 2, v112
    v_cndmask_b32 v117, v117, v158, vcc
    v_cmp_eq_u32 vcc, 3, v112
    v_cndmask_b32 v117, v117, v159, vcc
    v_cndmask_b32 v117, 0, v117, s[52:53]
    v_mov_b32 v118, v116
    s_nop 1
    v_permlane32_swap_b32 v116, v118
    s_nop 1
    v_add_f32 v116, v116, v118
    v_mov_b32 v118, v116
    s_nop 1
    v_permlane16_swap_b32 v116, v118
    s_nop 1
    v_add_f32 v116, v116, v118
    v_mov_b32 v118, v117
    s_nop 1
    v_permlane32_swap_b32 v117, v118
    s_nop 1
    v_add_f32 v117, v117, v118
    v_mov_b32 v118, v117
    s_nop 1
    v_permlane16_swap_b32 v117, v118
    s_nop 1
    v_add_f32 v117, v117, v118
    v_bfe_u32 v113, v0, 4, 1
    v_cmp_eq_u32 vcc, 1, v113
    v_cndmask_b32 v148, v144, v148, vcc
    v_cndmask_b32 v117, v116, v117, vcc
    v_mul_f32 v144, 0x3acccccd, v148
    v_mul_f32 v148, 0x3acccccd, v117
    v_fma_f32 v148, -v144, v144, v148
    v_max_f32 v148, 0, v148
    v_add_f32 v145, 0x3727c5ac, v148
    v_sub_f32 v152, 0, v144
    v_cvt_pk_bf16_f32 v153, v152, v152
    v_and_b32 v153, 0xffff0000, v153
    v_sub_f32 v153, v152, v153
    v_cvt_pk_bf16_f32 v152, v152, v153
    v_cmp_gt_u32 vcc, 32, v0
    v_cndmask_b32 v152, 0, v152, vcc
    v_mov_b32 v153, v152
    v_rsq_f32 v154, v145
    s_lshl_b32 s52, s28, 9
    s_add_u32 s52, s52, 151936
    v_lshlrev_b32 v155, 3, v0
    v_add_u32 v155, s52, v155
    ds_write_b64 v155, v[152:153]
    s_lshl_b32 s52, s28, 7
    s_add_u32 s52, s52, 156928
    v_and_b32 v156, 31, v0
    v_lshlrev_b32 v155, 2, v156
    v_add_u32 v155, s52, v155
    v_mul_f32 v157, 0xbfb8aa3b, v154
    ds_write_b32 v155, v154
    ds_write_b32 v155, v157 offset:512
    ds_write_b32 v155, v145 offset:1024
    s_waitcnt lgkmcnt(0)
    v_mov_b32 v156, 156592
    v_mov_b32 v157, 1
    s_mov_b64 exec, 1
    ds_add_u32 v156, v157
    s_mov_b64 exec, -1
    v_mov_b32 v156, 156596
    v_mov_b32 v157, 1
    s_mov_b64 exec, 1
    ds_add_u32 v156, v157
    s_mov_b64 exec, -1
    s_cmp_eq_u32 s69, 0
    s_cbranch_scc1 L_P_REPD
    v_lshrrev_b32 v12, 4, v0
    v_bfe_u32 v13, v0, 2, 2
    v_lshl_add_u32 v12, v12, 3, v13
    v_mul_u32_u24 v12, 160, v12
    v_and_b32 v13, 3, v0
    v_lshl_add_u32 v12, v13, 3, v12
    s_mul_i32 s52, s28, 5120
    s_add_u32 s52, s52, 16384
    v_add_u32 v12, s52, v12
    s_mul_i32 s52, s67, 68
    s_add_u32 s52, s52, s68
    s_mul_i32 s52, s52, 5120
    s_add_u32 s52, s52, 16908288
    v_lshlrev_b32 v13, 4, v0
    s_waitcnt vmcnt(0)
    ds_read_b64_tr_b16 v[64:65], v12 offset:0
    ds_read_b64_tr_b16 v[66:67], v12 offset:640
    ds_read_b64_tr_b16 v[68:69], v12 offset:32
    ds_read_b64_tr_b16 v[70:71], v12 offset:672
    ds_read_b64_tr_b16 v[72:73], v12 offset:64
    ds_read_b64_tr_b16 v[74:75], v12 offset:704
    ds_read_b64_tr_b16 v[76:77], v12 offset:96
    ds_read_b64_tr_b16 v[78:79], v12 offset:736
    ds_read_b64_tr_b16 v[80:81], v12 offset:128
    ds_read_b64_tr_b16 v[82:83], v12 offset:768
    s_waitcnt lgkmcnt(0)
    buffer_store_dwordx4 v[64:67], v13, s[32:35], s52 offen offset:0 sc1
    buffer_store_dwordx4 v[68:71], v13, s[32:35], s52 offen offset:1024 sc1
    buffer_store_dwordx4 v[72:75], v13, s[32:35], s52 offen offset:2048 sc1
    buffer_store_dwordx4 v[76:79], v13, s[32:35], s52 offen offset:3072 sc1
    s_add_u32 s52, s52, 4096
    buffer_store_dwordx4 v[80:83], v13, s[32:35], s52 offen sc1
L_P_REPD:
    s_endpgm
L_ROLE_A:
    s_and_b32 s29, s28, 1
    s_lshr_b32 s30, s28, 1
    s_mul_i32 s31, s27, 13
    s_lshr_b32 s31, s31, 6
    v_and_b32 v14, 31, v0
    v_lshrrev_b32 v15, 5, v0
    v_bfe_u32 v16, v0, 1, 3
    s_lshl_b32 s52, s29, 13
    v_lshlrev_b32 v14, 7, v14
    v_add_u32 v14, s52, v14
    v_xor_b32 v17, 0, v15
    v_xor_b32 v17, v17, v16
    v_lshl_add_u32 v2, v17, 4, v14
    v_xor_b32 v17, 2, v15
    v_xor_b32 v17, v17, v16
    v_lshl_add_u32 v3, v17, 4, v14
    v_xor_b32 v17, 4, v15
    v_xor_b32 v17, v17, v16
    v_lshl_add_u32 v4, v17, 4, v14
    v_xor_b32 v17, 6, v15
    v_xor_b32 v17, v17, v16
    v_lshl_add_u32 v5, v17, 4, v14
    v_lshrrev_b32 v14, 5, v0
    v_bfe_u32 v15, v0, 2, 2
    v_lshl_add_u32 v14, v14, 3, v15
    v_lshlrev_b32 v14, 8, v14
    v_bfe_u32 v16, v0, 4, 1
    v_lshl_add_u32 v14, v16, 5, v14
    v_and_b32 v16, 3, v0
    v_lshl_add_u32 v14, v16, 3, v14
    v_add_u32 v14, 49152, v14
    s_lshl_b32 s52, s30, 1
    s_add_u32 s53, s52, 0
    v_xor_b32 v16, s53, v15
    v_lshl_add_u32 v6, v16, 6, v14
    s_add_u32 s53, s52, 1
    v_xor_b32 v16, s53, v15
    v_lshl_add_u32 v7, v16, 6, v14
    v_and_b32 v8, 3, v0
    v_lshlrev_b32 v8, 2, v8
    v_add_u32 v8, 156544, v8
    s_lshl_b32 s53, s28, 2
    s_add_u32 s53, s53, 16
    v_lshlrev_b32 v10, 2, v0
    v_add_u32 v10, 156672, v10
    s_add_u32 s52, s53, 156544
    v_mov_b32 v1, s52
    v_cmp_eq_u32 vcc, 0, v0
    v_cndmask_b32 v10, v10, v1, vcc
    v_and_b32 v12, 15, v0
    v_bfe_u32 v13, v0, 4, 1
    v_cmp_eq_u32 vcc, v12, v13
    v_mov_b32 v13, 0x3f803f80
    v_cndmask_b32 v12, 0, v13, vcc
    v_mov_b32 v13, v12
    v_mov_b32 v14, v12
    v_mov_b32 v15, v12
    v_mov_b32 v16, 0
    v_mov_b32 v17, 0
    v_mov_b32 v18, 0
    v_mov_b32 v19, 0
    v_mov_b32 v20, 0
    v_mov_b32 v21, 0
    v_mov_b32 v22, 0
    v_mov_b32 v23, 0
    v_mov_b32 v24, 0
    v_mov_b32 v25, 0
    v_mov_b32 v26, 0
    v_mov_b32 v27, 0
    v_mov_b32 v28, 0
    v_mov_b32 v29, 0
    v_mov_b32 v30, 0
    v_mov_b32 v31, 0
    v_mov_b32 v32, 0
    v_mov_b32 v33, 0
    v_mov_b32 v34, 0
    v_mov_b32 v35, 0
    v_mov_b32 v36, 0
    v_mov_b32 v37, 0
    v_mov_b32 v38, 0
    v_mov_b32 v39, 0
    v_mov_b32 v40, 0
    v_mov_b32 v41, 0
    v_mov_b32 v42, 0
    v_mov_b32 v43, 0
    v_mov_b32 v44, 0
    v_mov_b32 v45, 0
    v_mov_b32 v46, 0
    v_mov_b32 v47, 0
    v_mov_b32 v48, 0
    v_mov_b32 v49, 0
    v_mov_b32 v50, 0
    v_mov_b32 v51, 0
    v_mov_b32 v52, 0
    v_mov_b32 v53, 0
    v_mov_b32 v54, 0
    v_mov_b32 v55, 0
    v_mov_b32 v56, 0
    v_mov_b32 v57, 0
    v_mov_b32 v58, 0
    v_mov_b32 v59, 0
    v_mov_b32 v60, 0
    v_mov_b32 v61, 0
    v_mov_b32 v62, 0
    v_mov_b32 v63, 0
    v_mov_b32 v64, 0
    v_mov_b32 v65, 0
    v_mov_b32 v66, 0
    v_mov_b32 v67, 0
    v_mov_b32 v68, 0
    v_mov_b32 v69, 0
    v_mov_b32 v70, 0
    v_mov_b32 v71, 0
    v_mov_b32 v72, 0
    v_mov_b32 v73, 0
    v_mov_b32 v74, 0
    v_mov_b32 v75, 0
    v_mov_b32 v76, 0
    v_mov_b32 v77, 0
    v_mov_b32 v78, 0
    v_mov_b32 v79, 0
    v_mov_b32 v144, 0
    v_mov_b32 v145, 0
    v_mov_b32 v146, 0
    v_mov_b32 v147, 0
    v_mov_b32 v148, 0
    v_mov_b32 v149, 0
    v_mov_b32 v150, 0
    v_mov_b32 v151, 0
    v_mov_b32 v11, 0
    s_mov_b32 s61, 0
    s_mov_b32 s62, 0x4000
    s_mov_b32 s64, 0
    s_mov_b32 s66, 4294934528
    s_mov_b32 s67, 0
    s_mov_b32 s68, 4294934528
    s_mov_b32 s70, 3
    s_mov_b32 s71, 0
L_A_W0:
    ds_read_b32 v9, v8
    s_waitcnt lgkmcnt(0)
    v_cmp_gt_u32 vcc, 1, v9
    s_cbranch_vccz L_A_W0_ok
    s_add_u32 s71, s71, 1
    s_cmp_lt_u32 s71, 200000
    s_cbranch_scc0 L_A_W0_ok
    s_sleep 1
    s_branch L_A_W0
L_A_W0_ok:
    ds_read_b128 v[80:83], v2 offset:0
    ds_read_b64_tr_b16 v[88:89], v6 offset:0
    ds_read_b64_tr_b16 v[90:91], v6 offset:1024
    ds_read_b64_tr_b16 v[92:93], v7 offset:0
    ds_read_b64_tr_b16 v[94:95], v7 offset:1024
    ds_read_b128 v[84:87], v2 offset:4096
    v_add_u32 v2, s62, v2
    ds_read_b128 v[96:99], v3 offset:0
    ds_read_b64_tr_b16 v[104:105], v6 offset:4096
    ds_read_b64_tr_b16 v[106:107], v6 offset:5120
    ds_read_b64_tr_b16 v[108:109], v7 offset:4096
    ds_read_b64_tr_b16 v[110:111], v7 offset:5120
    ds_read_b128 v[100:103], v3 offset:4096
    v_add_u32 v3, s62, v3
    s_add_u32 s67, s67, 1
    s_cmp_eq_u32 s67, 5
    s_cselect_b32 s63, s68, 8192
    s_cselect_b32 s67, 0, s67
    v_add_u32 v6, s63, v6
    v_add_u32 v7, s63, v7
    s_mov_b32 s71, 0
L_A_P2:
    ds_read_b32 v9, v8
    s_waitcnt lgkmcnt(0)
    v_cmp_gt_u32 vcc, 2, v9
    s_cbranch_vccz L_A_P2_ok
    s_add_u32 s71, s71, 1
    s_cmp_lt_u32 s71, 200000
    s_cbranch_scc0 L_A_P2_ok
    s_sleep 1
    s_branch L_A_P2
L_A_P2_ok:
    ds_read_b128 v[112:115], v4 offset:0
    ds_read_b64_tr_b16 v[120:121], v6 offset:0
    ds_read_b64_tr_b16 v[122:123], v6 offset:1024
    ds_read_b64_tr_b16 v[124:125], v7 offset:0
    ds_read_b64_tr_b16 v[126:127], v7 offset:1024
    ds_read_b128 v[116:119], v4 offset:4096
    v_add_u32 v4, s62, v4
    ds_read_b32 v9, v8
    s_waitcnt lgkmcnt(0)
    s_cmp_eq_u32 s31, 2
    s_cbranch_scc1 L_A_LOOPV
L_A_LOOP:
    s_waitcnt lgkmcnt(15)
    v_mfma_f32_32x32x16_bf16 v[16:31], v[88:91], v[80:83], v[16:31]
    ds_read_b128 v[128:131], v5 offset:0
    ds_read_b64_tr_b16 v[136:137], v6 offset:4096
    ds_read_b64_tr_b16 v[138:139], v6 offset:5120
    v_mfma_f32_32x32x16_bf16 v[32:47], v[92:95], v[80:83], v[32:47]
    ds_read_b64_tr_b16 v[140:141], v7 offset:4096
    ds_read_b64_tr_b16 v[142:143], v7 offset:5120
    s_waitcnt lgkmcnt(15)
    v_mfma_f32_32x32x16_bf16 v[48:63], v[88:91], v[84:87], v[48:63]
    ds_read_b128 v[132:135], v5 offset:4096
    v_add_u32 v5, s62, v5
    s_add_u32 s67, s67, 1
    s_cmp_eq_u32 s67, 5
    s_cselect_b32 s63, s68, 8192
    s_cselect_b32 s67, 0, s67
    v_add_u32 v6, s63, v6
    v_add_u32 v7, s63, v7
    s_add_u32 s64, s64, 1
    s_cmp_eq_u32 s64, 3
    s_cselect_b32 s64, 0, s64
    s_cmp_eq_u32 s64, 2
    s_cselect_b32 s62, s66, 0x4000
    v_mfma_f32_32x32x16_bf16 v[64:79], v[92:95], v[84:87], v[64:79]
    s_cmp_eq_u32 s29, 0
    s_cbranch_scc0 L_A_LOOP_C0
    v_mfma_f32_16x16x32_bf16 v[144:147], v[12:15], v[88:91], v[144:147]
    v_mfma_f32_16x16x32_bf16 v[148:151], v[12:15], v[92:95], v[148:151]
L_A_LOOP_C0:
    v_mfma_f32_32x32x16_bf16 v[16:31], v[104:107], v[96:99], v[16:31]
    s_waitcnt lgkmcnt(13)
    v_cmp_gt_u32 vcc, s70, v9
    s_cbranch_vccnz L_A_LOOP_S1
L_A_LOOP_B1:
    ds_read_b32 v9, v8
    s_add_u32 s70, s70, 1
    s_min_u32 s70, s70, 20
    ds_read_b128 v[80:83], v2 offset:0
    ds_read_b64_tr_b16 v[88:89], v6 offset:0
    ds_read_b64_tr_b16 v[90:91], v6 offset:1024
    v_mfma_f32_32x32x16_bf16 v[32:47], v[108:111], v[96:99], v[32:47]
    ds_read_b64_tr_b16 v[92:93], v7 offset:0
    ds_read_b64_tr_b16 v[94:95], v7 offset:1024
    v_add_u32 v11, 1, v11
    ds_write_b32 v10, v11
    v_mfma_f32_32x32x16_bf16 v[48:63], v[104:107], v[100:103], v[48:63]
    ds_read_b128 v[84:87], v2 offset:4096
    v_add_u32 v2, s62, v2
    v_mfma_f32_32x32x16_bf16 v[64:79], v[108:111], v[100:103], v[64:79]
    s_cmp_eq_u32 s29, 1
    s_cbranch_scc0 L_A_LOOP_C1
    v_mfma_f32_16x16x32_bf16 v[144:147], v[12:15], v[104:107], v[144:147]
    v_mfma_f32_16x16x32_bf16 v[148:151], v[12:15], v[108:111], v[148:151]
L_A_LOOP_C1:
    s_waitcnt lgkmcnt(15)
    v_mfma_f32_32x32x16_bf16 v[16:31], v[120:123], v[112:115], v[16:31]
    ds_read_b128 v[96:99], v3 offset:0
    ds_read_b64_tr_b16 v[104:105], v6 offset:4096
    ds_read_b64_tr_b16 v[106:107], v6 offset:5120
    v_mfma_f32_32x32x16_bf16 v[32:47], v[124:127], v[112:115], v[32:47]
    ds_read_b64_tr_b16 v[108:109], v7 offset:4096
    ds_read_b64_tr_b16 v[110:111], v7 offset:5120
    s_waitcnt lgkmcnt(15)
    v_mfma_f32_32x32x16_bf16 v[48:63], v[120:123], v[116:119], v[48:63]
    ds_read_b128 v[100:103], v3 offset:4096
    v_add_u32 v3, s62, v3
    s_add_u32 s67, s67, 1
    s_cmp_eq_u32 s67, 5
    s_cselect_b32 s63, s68, 8192
    s_cselect_b32 s67, 0, s67
    v_add_u32 v6, s63, v6
    v_add_u32 v7, s63, v7
    v_mfma_f32_32x32x16_bf16 v[64:79], v[124:127], v[116:119], v[64:79]
    s_cmp_eq_u32 s29, 0
    s_cbranch_scc0 L_A_LOOP_C2
    v_mfma_f32_16x16x32_bf16 v[144:147], v[12:15], v[120:123], v[144:147]
    v_mfma_f32_16x16x32_bf16 v[148:151], v[12:15], v[124:127], v[148:151]
L_A_LOOP_C2:
    v_mfma_f32_32x32x16_bf16 v[16:31], v[136:139], v[128:131], v[16:31]
    s_waitcnt lgkmcnt(13)
    v_cmp_gt_u32 vcc, s70, v9
    s_cbranch_vccnz L_A_LOOP_S3
L_A_LOOP_B3:
    ds_read_b32 v9, v8
    s_add_u32 s70, s70, 1
    s_min_u32 s70, s70, 20
    ds_read_b128 v[112:115], v4 offset:0
    ds_read_b64_tr_b16 v[120:121], v6 offset:0
    ds_read_b64_tr_b16 v[122:123], v6 offset:1024
    v_mfma_f32_32x32x16_bf16 v[32:47], v[140:143], v[128:131], v[32:47]
    ds_read_b64_tr_b16 v[124:125], v7 offset:0
    ds_read_b64_tr_b16 v[126:127], v7 offset:1024
    v_add_u32 v11, 1, v11
    ds_write_b32 v10, v11
    v_mfma_f32_32x32x16_bf16 v[48:63], v[136:139], v[132:135], v[48:63]
    ds_read_b128 v[116:119], v4 offset:4096
    v_add_u32 v4, s62, v4
    v_mfma_f32_32x32x16_bf16 v[64:79], v[140:143], v[132:135], v[64:79]
    s_cmp_eq_u32 s29, 1
    s_cbranch_scc0 L_A_LOOP_C3
    v_mfma_f32_16x16x32_bf16 v[144:147], v[12:15], v[136:139], v[144:147]
    v_mfma_f32_16x16x32_bf16 v[148:151], v[12:15], v[140:143], v[148:151]
L_A_LOOP_C3:
    s_add_u32 s61, s61, 1
    s_cmp_lt_u32 s61, 10
    s_cbranch_scc1 L_A_LOOP
    s_branch L_A_P1A_DONE
L_A_LOOP_S1:
    s_mov_b32 s71, 0
L_A_LOOP_SL1:
    ds_read_b32 v9, v8
    s_waitcnt lgkmcnt(0)
    v_cmp_gt_u32 vcc, s70, v9
    s_cbranch_vccz L_A_LOOP_B1
    s_add_u32 s71, s71, 1
    s_cmp_lt_u32 s71, 200000
    s_cbranch_scc1 L_A_LOOP_SL1
    s_branch L_A_LOOP_B1
L_A_LOOP_S3:
    s_mov_b32 s71, 0
L_A_LOOP_SL3:
    ds_read_b32 v9, v8
    s_waitcnt lgkmcnt(0)
    v_cmp_gt_u32 vcc, s70, v9
    s_cbranch_vccz L_A_LOOP_B3
    s_add_u32 s71, s71, 1
    s_cmp_lt_u32 s71, 200000
    s_cbranch_scc1 L_A_LOOP_SL3
    s_branch L_A_LOOP_B3
L_A_LOOPV:
    s_waitcnt lgkmcnt(15)
    v_mfma_f32_32x32x16_bf16 v[16:31], v[80:83], v[88:91], v[16:31]
    ds_read_b128 v[128:131], v5 offset:0
    ds_read_b64_tr_b16 v[136:137], v6 offset:4096
    ds_read_b64_tr_b16 v[138:139], v6 offset:5120
    v_mfma_f32_32x32x16_bf16 v[32:47], v[80:83], v[92:95], v[32:47]
    ds_read_b64_tr_b16 v[140:141], v7 offset:4096
    ds_read_b64_tr_b16 v[142:143], v7 offset:5120
    s_waitcnt lgkmcnt(15)
    v_mfma_f32_32x32x16_bf16 v[48:63], v[84:87], v[88:91], v[48:63]
    ds_read_b128 v[132:135], v5 offset:4096
    v_add_u32 v5, s62, v5
    s_add_u32 s67, s67, 1
    s_cmp_eq_u32 s67, 5
    s_cselect_b32 s63, s68, 8192
    s_cselect_b32 s67, 0, s67
    v_add_u32 v6, s63, v6
    v_add_u32 v7, s63, v7
    s_add_u32 s64, s64, 1
    s_cmp_eq_u32 s64, 3
    s_cselect_b32 s64, 0, s64
    s_cmp_eq_u32 s64, 2
    s_cselect_b32 s62, s66, 0x4000
    v_mfma_f32_32x32x16_bf16 v[64:79], v[84:87], v[92:95], v[64:79]
    s_cmp_eq_u32 s29, 0
    s_cbranch_scc0 L_A_LOOPV_C0
    v_mfma_f32_16x16x32_bf16 v[144:147], v[12:15], v[88:91], v[144:147]
    v_mfma_f32_16x16x32_bf16 v[148:151], v[12:15], v[92:95], v[148:151]
L_A_LOOPV_C0:
    v_mfma_f32_32x32x16_bf16 v[16:31], v[96:99], v[104:107], v[16:31]
    s_waitcnt lgkmcnt(13)
    v_cmp_gt_u32 vcc, s70, v9
    s_cbranch_vccnz L_A_LOOPV_S1
L_A_LOOPV_B1:
    ds_read_b32 v9, v8
    s_add_u32 s70, s70, 1
    s_min_u32 s70, s70, 20
    ds_read_b128 v[80:83], v2 offset:0
    ds_read_b64_tr_b16 v[88:89], v6 offset:0
    ds_read_b64_tr_b16 v[90:91], v6 offset:1024
    v_mfma_f32_32x32x16_bf16 v[32:47], v[96:99], v[108:111], v[32:47]
    ds_read_b64_tr_b16 v[92:93], v7 offset:0
    ds_read_b64_tr_b16 v[94:95], v7 offset:1024
    v_add_u32 v11, 1, v11
    ds_write_b32 v10, v11
    v_mfma_f32_32x32x16_bf16 v[48:63], v[100:103], v[104:107], v[48:63]
    ds_read_b128 v[84:87], v2 offset:4096
    v_add_u32 v2, s62, v2
    v_mfma_f32_32x32x16_bf16 v[64:79], v[100:103], v[108:111], v[64:79]
    s_cmp_eq_u32 s29, 1
    s_cbranch_scc0 L_A_LOOPV_C1
    v_mfma_f32_16x16x32_bf16 v[144:147], v[12:15], v[104:107], v[144:147]
    v_mfma_f32_16x16x32_bf16 v[148:151], v[12:15], v[108:111], v[148:151]
L_A_LOOPV_C1:
    s_waitcnt lgkmcnt(15)
    v_mfma_f32_32x32x16_bf16 v[16:31], v[112:115], v[120:123], v[16:31]
    ds_read_b128 v[96:99], v3 offset:0
    ds_read_b64_tr_b16 v[104:105], v6 offset:4096
    ds_read_b64_tr_b16 v[106:107], v6 offset:5120
    v_mfma_f32_32x32x16_bf16 v[32:47], v[112:115], v[124:127], v[32:47]
    ds_read_b64_tr_b16 v[108:109], v7 offset:4096
    ds_read_b64_tr_b16 v[110:111], v7 offset:5120
    s_waitcnt lgkmcnt(15)
    v_mfma_f32_32x32x16_bf16 v[48:63], v[116:119], v[120:123], v[48:63]
    ds_read_b128 v[100:103], v3 offset:4096
    v_add_u32 v3, s62, v3
    s_add_u32 s67, s67, 1
    s_cmp_eq_u32 s67, 5
    s_cselect_b32 s63, s68, 8192
    s_cselect_b32 s67, 0, s67
    v_add_u32 v6, s63, v6
    v_add_u32 v7, s63, v7
    v_mfma_f32_32x32x16_bf16 v[64:79], v[116:119], v[124:127], v[64:79]
    s_cmp_eq_u32 s29, 0
    s_cbranch_scc0 L_A_LOOPV_C2
    v_mfma_f32_16x16x32_bf16 v[144:147], v[12:15], v[120:123], v[144:147]
    v_mfma_f32_16x16x32_bf16 v[148:151], v[12:15], v[124:127], v[148:151]
L_A_LOOPV_C2:
    v_mfma_f32_32x32x16_bf16 v[16:31], v[128:131], v[136:139], v[16:31]
    s_waitcnt lgkmcnt(13)
    v_cmp_gt_u32 vcc, s70, v9
    s_cbranch_vccnz L_A_LOOPV_S3
L_A_LOOPV_B3:
    ds_read_b32 v9, v8
    s_add_u32 s70, s70, 1
    s_min_u32 s70, s70, 20
    ds_read_b128 v[112:115], v4 offset:0
    ds_read_b64_tr_b16 v[120:121], v6 offset:0
    ds_read_b64_tr_b16 v[122:123], v6 offset:1024
    v_mfma_f32_32x32x16_bf16 v[32:47], v[128:131], v[140:143], v[32:47]
    ds_read_b64_tr_b16 v[124:125], v7 offset:0
    ds_read_b64_tr_b16 v[126:127], v7 offset:1024
    v_add_u32 v11, 1, v11
    ds_write_b32 v10, v11
    v_mfma_f32_32x32x16_bf16 v[48:63], v[132:135], v[136:139], v[48:63]
    ds_read_b128 v[116:119], v4 offset:4096
    v_add_u32 v4, s62, v4
    v_mfma_f32_32x32x16_bf16 v[64:79], v[132:135], v[140:143], v[64:79]
    s_cmp_eq_u32 s29, 1
    s_cbranch_scc0 L_A_LOOPV_C3
    v_mfma_f32_16x16x32_bf16 v[144:147], v[12:15], v[136:139], v[144:147]
    v_mfma_f32_16x16x32_bf16 v[148:151], v[12:15], v[140:143], v[148:151]
L_A_LOOPV_C3:
    s_add_u32 s61, s61, 1
    s_cmp_lt_u32 s61, 10
    s_cbranch_scc1 L_A_LOOPV
    s_branch L_A_P1A_DONE
L_A_LOOPV_S1:
    s_mov_b32 s71, 0
L_A_LOOPV_SL1:
    ds_read_b32 v9, v8
    s_waitcnt lgkmcnt(0)
    v_cmp_gt_u32 vcc, s70, v9
    s_cbranch_vccz L_A_LOOPV_B1
    s_add_u32 s71, s71, 1
    s_cmp_lt_u32 s71, 200000
    s_cbranch_scc1 L_A_LOOPV_SL1
    s_branch L_A_LOOPV_B1
L_A_LOOPV_S3:
    s_mov_b32 s71, 0
L_A_LOOPV_SL3:
    ds_read_b32 v9, v8
    s_waitcnt lgkmcnt(0)
    v_cmp_gt_u32 vcc, s70, v9
    s_cbranch_vccz L_A_LOOPV_B3
    s_add_u32 s71, s71, 1
    s_cmp_lt_u32 s71, 200000
    s_cbranch_scc1 L_A_LOOPV_SL3
    s_branch L_A_LOOPV_B3
L_A_P1A_DONE:
    s_nop 7
    s_waitcnt lgkmcnt(0)
    s_lshl_b32 s52, s30, 1
    s_add_u32 s52, s52, s29
    s_mul_i32 s52, s52, 256
    s_add_u32 s52, s52, 153984
    v_lshlrev_b32 v2, 2, v0
    v_add_u32 v2, s52, v2
    s_mov_b64 exec, 0xffff
    ds_write2_b32 v2, v144, v145 offset0:0 offset1:16
    ds_write2_b32 v2, v148, v149 offset0:32 offset1:48
    s_mov_b64 exec, -1
    s_waitcnt lgkmcnt(0)
    v_mov_b32 v2, 156592
    v_mov_b32 v3, 1
    s_mov_b64 exec, 1
    ds_add_u32 v2, v3
    s_mov_b64 exec, -1
    v_mov_b32 v8, 156592
    s_mov_b32 s71, 0
L_A_TAB:
    ds_read_b32 v9, v8
    s_waitcnt lgkmcnt(0)
    v_cmp_gt_u32 vcc, 8, v9
    s_cbranch_vccz L_A_TAB_ok
    s_add_u32 s71, s71, 1
    s_cmp_lt_u32 s71, 200000
    s_cbranch_scc0 L_A_TAB_ok
    s_sleep 1
    s_branch L_A_TAB
L_A_TAB_ok:
    v_lshlrev_b32 v2, 3, v0
    s_lshl_b32 s52, s29, 10
    s_add_u32 s52, s52, 151936
    v_add_u32 v3, s52, v2
    ds_read_b64 v[80:81], v3
    ds_read_b64 v[84:85], v3 offset:512
    v_mov_b32 v82, 0
    v_mov_b32 v83, 0
    v_mov_b32 v86, 0
    v_mov_b32 v87, 0
    s_mul_i32 s52, s30, 512
    s_add_u32 s52, s52, 153984
    v_and_b32 v3, 31, v0
    v_lshlrev_b32 v3, 2, v3
    v_add_u32 v3, s52, v3
    ds_read_b32 v88, v3 offset:0
    ds_read_b32 v89, v3 offset:256
    ds_read_b32 v92, v3 offset:128
    ds_read_b32 v93, v3 offset:384
    v_cmp_gt_u32 vcc, 32, v0
    s_waitcnt lgkmcnt(0)
    v_add_f32 v90, v88, v89
    v_cndmask_b32 v90, 0, v90, vcc
    v_cvt_pk_bf16_f32 v88, v90, v90
    v_and_b32 v91, 0xffff0000, v88
    v_sub_f32 v91, v90, v91
    v_cvt_pk_bf16_f32 v89, v91, v91
    v_mov_b32 v90, 0
    v_mov_b32 v91, 0
    v_add_f32 v94, v92, v93
    v_cndmask_b32 v94, 0, v94, vcc
    v_cvt_pk_bf16_f32 v92, v94, v94
    v_and_b32 v95, 0xffff0000, v92
    v_sub_f32 v95, v94, v95
    v_cvt_pk_bf16_f32 v93, v95, v95
    v_mov_b32 v94, 0
    v_mov_b32 v95, 0
    v_and_b32 v4, 31, v0
    v_lshrrev_b32 v5, 5, v0
    s_lshl_b32 s52, s29, 8
    s_add_u32 s52, s52, 156928
    v_lshlrev_b32 v3, 2, v4
    v_add_u32 v3, s52, v3
    ds_read_b32 v96, v3
    ds_read_b32 v97, v3 offset:128
    s_waitcnt lgkmcnt(0)
    s_cmp_eq_u32 s31, 2
    s_cbranch_scc1 L_A_FOLDV
    v_mfma_f32_32x32x16_bf16 v[16:31], v[88:91], v[80:83], v[16:31]
    v_mfma_f32_32x32x16_bf16 v[32:47], v[92:95], v[80:83], v[32:47]
    v_mfma_f32_32x32x16_bf16 v[48:63], v[88:91], v[84:87], v[48:63]
    v_mfma_f32_32x32x16_bf16 v[64:79], v[92:95], v[84:87], v[64:79]
    s_branch L_A_FOLDD
L_A_FOLDV:
    v_mfma_f32_32x32x16_bf16 v[16:31], v[80:83], v[88:91], v[16:31]
    v_mfma_f32_32x32x16_bf16 v[32:47], v[80:83], v[92:95], v[32:47]
    v_mfma_f32_32x32x16_bf16 v[48:63], v[84:87], v[88:91], v[48:63]
    v_mfma_f32_32x32x16_bf16 v[64:79], v[84:87], v[92:95], v[64:79]
L_A_FOLDD:
    s_cmp_eq_u32 s31, 0
    s_cselect_b32 s52, 0x3ea52b5c, 1.0
    v_mul_f32 v96, s52, v96
    v_mul_f32 v97, s52, v97
    v_lshlrev_b32 v6, 4, v4
    v_mul_u32_u24 v7, 32768, v5
    v_add_u32 v7, v7, v6
    v_mul_u32_u24 v8, 10240, v5
    v_add_u32 v8, v8, v6
    s_mul_i32 s52, s31, 5
    s_sub_u32 s52, s27, s52
    s_lshl_b32 s53, s52, 4
    s_lshl_b32 s54, s30, 3
    s_add_u32 s53, s53, s54
    s_mul_i32 s54, s31, 80
    s_add_u32 s53, s53, s54
    s_mul_i32 s53, s53, 32768
    s_lshl_b32 s54, s25, 7
    s_lshl_b32 s55, s29, 6
    s_add_u32 s54, s54, s55
    s_lshl_b32 s55, s54, 4
    s_add_u32 s53, s53, s55
    s_add_u32 s56, s53, 131072
    s_lshr_b32 s54, s54, 4
    s_mul_i32 s54, s54, 20480
    s_lshl_b32 s52, s52, 7
    s_lshl_b32 s55, s30, 6
    s_add_u32 s52, s52, s55
    s_lshl_b32 s52, s52, 4
    s_add_u32 s54, s54, s52
    s_add_u32 s57, s54, 5373952
    s_lshl_b32 s52, s29, 8
    v_lshlrev_b32 v9, 4, v5
    v_add_u32 v9, s52, v9
    v_add_u32 v9, 156928, v9
    s_cmp_eq_u32 s26, 15
    s_cbranch_scc1 L_A_EPI_D
    s_cmp_eq_u32 s31, 2
    s_cbranch_scc1 L_A_EPI_V
    v_mul_f32 v16, v96, v16
    v_mul_f32 v17, v96, v17
    v_mul_f32 v18, v96, v18
    v_mul_f32 v19, v96, v19
    v_mul_f32 v20, v96, v20
    v_mul_f32 v21, v96, v21
    v_mul_f32 v22, v96, v22
    v_mul_f32 v23, v96, v23
    v_cvt_pk_bf16_f32 v100, v16, v17
    v_cvt_pk_bf16_f32 v101, v18, v19
    v_cvt_pk_bf16_f32 v102, v20, v21
    v_cvt_pk_bf16_f32 v103, v22, v23
    s_add_u32 s52, s56, 0
    s_nop 0
    v_permlane32_swap_b32 v100, v102
    v_permlane32_swap_b32 v101, v103
    buffer_store_dwordx4 v[100:103], v7, s[32:35], s52 offen sc1
    v_mul_f32 v24, v96, v24
    v_mul_f32 v25, v96, v25
    v_mul_f32 v26, v96, v26
    v_mul_f32 v27, v96, v27
    v_mul_f32 v28, v96, v28
    v_mul_f32 v29, v96, v29
    v_mul_f32 v30, v96, v30
    v_mul_f32 v31, v96, v31
    v_cvt_pk_bf16_f32 v104, v24, v25
    v_cvt_pk_bf16_f32 v105, v26, v27
    v_cvt_pk_bf16_f32 v106, v28, v29
    v_cvt_pk_bf16_f32 v107, v30, v31
    s_add_u32 s52, s56, 65536
    s_nop 0
    v_permlane32_swap_b32 v104, v106
    v_permlane32_swap_b32 v105, v107
    buffer_store_dwordx4 v[104:107], v7, s[32:35], s52 offen sc1
    v_mul_f32 v32, v96, v32
    v_mul_f32 v33, v96, v33
    v_mul_f32 v34, v96, v34
    v_mul_f32 v35, v96, v35
    v_mul_f32 v36, v96, v36
    v_mul_f32 v37, v96, v37
    v_mul_f32 v38, v96, v38
    v_mul_f32 v39, v96, v39
    v_cvt_pk_bf16_f32 v100, v32, v33
    v_cvt_pk_bf16_f32 v101, v34, v35
    v_cvt_pk_bf16_f32 v102, v36, v37
    v_cvt_pk_bf16_f32 v103, v38, v39
    s_add_u32 s52, s56, 131072
    s_nop 0
    v_permlane32_swap_b32 v100, v102
    v_permlane32_swap_b32 v101, v103
    buffer_store_dwordx4 v[100:103], v7, s[32:35], s52 offen sc1
    v_mul_f32 v40, v96, v40
    v_mul_f32 v41, v96, v41
    v_mul_f32 v42, v96, v42
    v_mul_f32 v43, v96, v43
    v_mul_f32 v44, v96, v44
    v_mul_f32 v45, v96, v45
    v_mul_f32 v46, v96, v46
    v_mul_f32 v47, v96, v47
    v_cvt_pk_bf16_f32 v104, v40, v41
    v_cvt_pk_bf16_f32 v105, v42, v43
    v_cvt_pk_bf16_f32 v106, v44, v45
    v_cvt_pk_bf16_f32 v107, v46, v47
    s_add_u32 s52, s56, 196608
    s_nop 0
    v_permlane32_swap_b32 v104, v106
    v_permlane32_swap_b32 v105, v107
    buffer_store_dwordx4 v[104:107], v7, s[32:35], s52 offen sc1
    v_mul_f32 v48, v97, v48
    v_mul_f32 v49, v97, v49
    v_mul_f32 v50, v97, v50
    v_mul_f32 v51, v97, v51
    v_mul_f32 v52, v97, v52
    v_mul_f32 v53, v97, v53
    v_mul_f32 v54, v97, v54
    v_mul_f32 v55, v97, v55
    v_cvt_pk_bf16_f32 v100, v48, v49
    v_cvt_pk_bf16_f32 v101, v50, v51
    v_cvt_pk_bf16_f32 v102, v52, v53
    v_cvt_pk_bf16_f32 v103, v54, v55
    s_add_u32 s52, s56, 512
    s_nop 0
    v_permlane32_swap_b32 v100, v102
    v_permlane32_swap_b32 v101, v103
    buffer_store_dwordx4 v[100:103], v7, s[32:35], s52 offen sc1
    v_mul_f32 v56, v97, v56
    v_mul_f32 v57, v97, v57
    v_mul_f32 v58, v97, v58
    v_mul_f32 v59, v97, v59
    v_mul_f32 v60, v97, v60
    v_mul_f32 v61, v97, v61
    v_mul_f32 v62, v97, v62
    v_mul_f32 v63, v97, v63
    v_cvt_pk_bf16_f32 v104, v56, v57
    v_cvt_pk_bf16_f32 v105, v58, v59
    v_cvt_pk_bf16_f32 v106, v60, v61
    v_cvt_pk_bf16_f32 v107, v62, v63
    s_add_u32 s52, s56, 66048
    s_nop 0
    v_permlane32_swap_b32 v104, v106
    v_permlane32_swap_b32 v105, v107
    buffer_store_dwordx4 v[104:107], v7, s[32:35], s52 offen sc1
    v_mul_f32 v64, v97, v64
    v_mul_f32 v65, v97, v65
    v_mul_f32 v66, v97, v66
    v_mul_f32 v67, v97, v67
    v_mul_f32 v68, v97, v68
    v_mul_f32 v69, v97, v69
    v_mul_f32 v70, v97, v70
    v_mul_f32 v71, v97, v71
    v_cvt_pk_bf16_f32 v100, v64, v65
    v_cvt_pk_bf16_f32 v101, v66, v67
    v_cvt_pk_bf16_f32 v102, v68, v69
    v_cvt_pk_bf16_f32 v103, v70, v71
    s_add_u32 s52, s56, 131584
    s_nop 0
    v_permlane32_swap_b32 v100, v102
    v_permlane32_swap_b32 v101, v103
    buffer_store_dwordx4 v[100:103], v7, s[32:35], s52 offen sc1
    v_mul_f32 v72, v97, v72
    v_mul_f32 v73, v97, v73
    v_mul_f32 v74, v97, v74
    v_mul_f32 v75, v97, v75
    v_mul_f32 v76, v97, v76
    v_mul_f32 v77, v97, v77
    v_mul_f32 v78, v97, v78
    v_mul_f32 v79, v97, v79
    v_cvt_pk_bf16_f32 v104, v72, v73
    v_cvt_pk_bf16_f32 v105, v74, v75
    v_cvt_pk_bf16_f32 v106, v76, v77
    v_cvt_pk_bf16_f32 v107, v78, v79
    s_add_u32 s52, s56, 197120
    s_nop 0
    v_permlane32_swap_b32 v104, v106
    v_permlane32_swap_b32 v105, v107
    buffer_store_dwordx4 v[104:107], v7, s[32:35], s52 offen sc1
    s_branch L_A_EPI_D
L_A_EPI_V:
    ds_read_b128 v[108:111], v9 offset:0
    ds_read_b128 v[112:115], v9 offset:32
    ds_read_b128 v[116:119], v9 offset:64
    ds_read_b128 v[120:123], v9 offset:96
    s_waitcnt lgkmcnt(0)
    v_mul_f32 v16, v108, v16
    v_mul_f32 v17, v109, v17
    v_mul_f32 v18, v110, v18
    v_mul_f32 v19, v111, v19
    v_mul_f32 v20, v112, v20
    v_mul_f32 v21, v113, v21
    v_mul_f32 v22, v114, v22
    v_mul_f32 v23, v115, v23
    v_cvt_pk_bf16_f32 v100, v16, v17
    v_cvt_pk_bf16_f32 v101, v18, v19
    v_cvt_pk_bf16_f32 v102, v20, v21
    v_cvt_pk_bf16_f32 v103, v22, v23
    s_add_u32 s52, s57, 0
    buffer_store_dwordx4 v[100:103], v8, s[32:35], s52 offen sc1
    v_mul_f32 v24, v116, v24
    v_mul_f32 v25, v117, v25
    v_mul_f32 v26, v118, v26
    v_mul_f32 v27, v119, v27
    v_mul_f32 v28, v120, v28
    v_mul_f32 v29, v121, v29
    v_mul_f32 v30, v122, v30
    v_mul_f32 v31, v123, v31
    v_cvt_pk_bf16_f32 v104, v24, v25
    v_cvt_pk_bf16_f32 v105, v26, v27
    v_cvt_pk_bf16_f32 v106, v28, v29
    v_cvt_pk_bf16_f32 v107, v30, v31
    s_add_u32 s52, s57, 20480
    buffer_store_dwordx4 v[104:107], v8, s[32:35], s52 offen sc1
    v_mul_f32 v32, v108, v32
    v_mul_f32 v33, v109, v33
    v_mul_f32 v34, v110, v34
    v_mul_f32 v35, v111, v35
    v_mul_f32 v36, v112, v36
    v_mul_f32 v37, v113, v37
    v_mul_f32 v38, v114, v38
    v_mul_f32 v39, v115, v39
    v_cvt_pk_bf16_f32 v100, v32, v33
    v_cvt_pk_bf16_f32 v101, v34, v35
    v_cvt_pk_bf16_f32 v102, v36, v37
    v_cvt_pk_bf16_f32 v103, v38, v39
    s_add_u32 s52, s57, 512
    buffer_store_dwordx4 v[100:103], v8, s[32:35], s52 offen sc1
    v_mul_f32 v40, v116, v40
    v_mul_f32 v41, v117, v41
    v_mul_f32 v42, v118, v42
    v_mul_f32 v43, v119, v43
    v_mul_f32 v44, v120, v44
    v_mul_f32 v45, v121, v45
    v_mul_f32 v46, v122, v46
    v_mul_f32 v47, v123, v47
    v_cvt_pk_bf16_f32 v104, v40, v41
    v_cvt_pk_bf16_f32 v105, v42, v43
    v_cvt_pk_bf16_f32 v106, v44, v45
    v_cvt_pk_bf16_f32 v107, v46, v47
    s_add_u32 s52, s57, 20992
    buffer_store_dwordx4 v[104:107], v8, s[32:35], s52 offen sc1
    ds_read_b128 v[108:111], v9 offset:128
    ds_read_b128 v[112:115], v9 offset:160
    ds_read_b128 v[116:119], v9 offset:192
    ds_read_b128 v[120:123], v9 offset:224
    s_waitcnt lgkmcnt(0)
    v_mul_f32 v48, v108, v48
    v_mul_f32 v49, v109, v49
    v_mul_f32 v50, v110, v50
    v_mul_f32 v51, v111, v51
    v_mul_f32 v52, v112, v52
    v_mul_f32 v53, v113, v53
    v_mul_f32 v54, v114, v54
    v_mul_f32 v55, v115, v55
    v_cvt_pk_bf16_f32 v100, v48, v49
    v_cvt_pk_bf16_f32 v101, v50, v51
    v_cvt_pk_bf16_f32 v102, v52, v53
    v_cvt_pk_bf16_f32 v103, v54, v55
    s_add_u32 s52, s57, 40960
    buffer_store_dwordx4 v[100:103], v8, s[32:35], s52 offen sc1
    v_mul_f32 v56, v116, v56
    v_mul_f32 v57, v117, v57
    v_mul_f32 v58, v118, v58
    v_mul_f32 v59, v119, v59
    v_mul_f32 v60, v120, v60
    v_mul_f32 v61, v121, v61
    v_mul_f32 v62, v122, v62
    v_mul_f32 v63, v123, v63
    v_cvt_pk_bf16_f32 v104, v56, v57
    v_cvt_pk_bf16_f32 v105, v58, v59
    v_cvt_pk_bf16_f32 v106, v60, v61
    v_cvt_pk_bf16_f32 v107, v62, v63
    s_add_u32 s52, s57, 61440
    buffer_store_dwordx4 v[104:107], v8, s[32:35], s52 offen sc1
    v_mul_f32 v64, v108, v64
    v_mul_f32 v65, v109, v65
    v_mul_f32 v66, v110, v66
    v_mul_f32 v67, v111, v67
    v_mul_f32 v68, v112, v68
    v_mul_f32 v69, v113, v69
    v_mul_f32 v70, v114, v70
    v_mul_f32 v71, v115, v71
    v_cvt_pk_bf16_f32 v100, v64, v65
    v_cvt_pk_bf16_f32 v101, v66, v67
    v_cvt_pk_bf16_f32 v102, v68, v69
    v_cvt_pk_bf16_f32 v103, v70, v71
    s_add_u32 s52, s57, 41472
    buffer_store_dwordx4 v[100:103], v8, s[32:35], s52 offen sc1
    v_mul_f32 v72, v116, v72
    v_mul_f32 v73, v117, v73
    v_mul_f32 v74, v118, v74
    v_mul_f32 v75, v119, v75
    v_mul_f32 v76, v120, v76
    v_mul_f32 v77, v121, v77
    v_mul_f32 v78, v122, v78
    v_mul_f32 v79, v123, v79
    v_cvt_pk_bf16_f32 v104, v72, v73
    v_cvt_pk_bf16_f32 v105, v74, v75
    v_cvt_pk_bf16_f32 v106, v76, v77
    v_cvt_pk_bf16_f32 v107, v78, v79
    s_add_u32 s52, s57, 61952
    buffer_store_dwordx4 v[104:107], v8, s[32:35], s52 offen sc1
L_A_EPI_D:
    s_endpgm
L_ROLE_B:
    s_and_b32 s29, s28, 1
    s_lshr_b32 s30, s28, 1
    v_and_b32 v14, 31, v0
    v_lshrrev_b32 v15, 5, v0
    v_bfe_u32 v16, v0, 1, 3
    s_lshl_b32 s52, s29, 13
    v_lshlrev_b32 v14, 7, v14
    v_add_u32 v14, s52, v14
    v_xor_b32 v17, 0, v15
    v_xor_b32 v17, v17, v16
    v_lshl_add_u32 v2, v17, 4, v14
    v_xor_b32 v17, 2, v15
    v_xor_b32 v17, v17, v16
    v_lshl_add_u32 v3, v17, 4, v14
    v_xor_b32 v17, 4, v15
    v_xor_b32 v17, v17, v16
    v_lshl_add_u32 v4, v17, 4, v14
    v_xor_b32 v17, 6, v15
    v_xor_b32 v17, v17, v16
    v_lshl_add_u32 v5, v17, 4, v14
    v_lshrrev_b32 v14, 5, v0
    v_bfe_u32 v15, v0, 2, 2
    v_lshl_add_u32 v14, v14, 3, v15
    v_mul_u32_u24 v14, 192, v14
    v_bfe_u32 v16, v0, 4, 1
    v_mul_u32_u24 v16, 6176, v16
    v_add_u32 v14, v14, v16
    v_and_b32 v16, 3, v0
    v_lshl_add_u32 v14, v16, 3, v14
    s_mul_i32 s52, s30, 96
    s_add_u32 s52, s52, 90112
    v_add_u32 v6, s52, v14
    v_and_b32 v8, 3, v0
    v_lshlrev_b32 v8, 2, v8
    v_add_u32 v8, 156544, v8
    s_lshl_b32 s53, s28, 2
    s_add_u32 s53, s53, 32
    v_lshlrev_b32 v10, 2, v0
    v_add_u32 v10, 156672, v10
    s_add_u32 s52, s53, 156544
    v_mov_b32 v1, s52
    v_cmp_eq_u32 vcc, 0, v0
    v_cndmask_b32 v10, v10, v1, vcc
    v_and_b32 v12, 15, v0
    v_bfe_u32 v13, v0, 4, 1
    v_cmp_eq_u32 vcc, v12, v13
    v_mov_b32 v13, 0x3f803f80
    v_cndmask_b32 v12, 0, v13, vcc
    v_mov_b32 v13, v12
    v_mov_b32 v14, v12
    v_mov_b32 v15, v12
    v_mov_b32 v16, 0
    v_mov_b32 v17, 0
    v_mov_b32 v18, 0
    v_mov_b32 v19, 0
    v_mov_b32 v20, 0
    v_mov_b32 v21, 0
    v_mov_b32 v22, 0
    v_mov_b32 v23, 0
    v_mov_b32 v24, 0
    v_mov_b32 v25, 0
    v_mov_b32 v26, 0
    v_mov_b32 v27, 0
    v_mov_b32 v28, 0
    v_mov_b32 v29, 0
    v_mov_b32 v30, 0
    v_mov_b32 v31, 0
    v_mov_b32 v32, 0
    v_mov_b32 v33, 0
    v_mov_b32 v34, 0
    v_mov_b32 v35, 0
    v_mov_b32 v36, 0
    v_mov_b32 v37, 0
    v_mov_b32 v38, 0
    v_mov_b32 v39, 0
    v_mov_b32 v40, 0
    v_mov_b32 v41, 0
    v_mov_b32 v42, 0
    v_mov_b32 v43, 0
    v_mov_b32 v44, 0
    v_mov_b32 v45, 0
    v_mov_b32 v46, 0
    v_mov_b32 v47, 0
    v_mov_b32 v48, 0
    v_mov_b32 v49, 0
    v_mov_b32 v50, 0
    v_mov_b32 v51, 0
    v_mov_b32 v52, 0
    v_mov_b32 v53, 0
    v_mov_b32 v54, 0
    v_mov_b32 v55, 0
    v_mov_b32 v56, 0
    v_mov_b32 v57, 0
    v_mov_b32 v58, 0
    v_mov_b32 v59, 0
    v_mov_b32 v60, 0
    v_mov_b32 v61, 0
    v_mov_b32 v62, 0
    v_mov_b32 v63, 0
    v_mov_b32 v64, 0
    v_mov_b32 v65, 0
    v_mov_b32 v66, 0
    v_mov_b32 v67, 0
    v_mov_b32 v68, 0
    v_mov_b32 v69, 0
    v_mov_b32 v70, 0
    v_mov_b32 v71, 0
    v_mov_b32 v72, 0
    v_mov_b32 v73, 0
    v_mov_b32 v74, 0
    v_mov_b32 v75, 0
    v_mov_b32 v76, 0
    v_mov_b32 v77, 0
    v_mov_b32 v78, 0
    v_mov_b32 v79, 0
    v_mov_b32 v80, 0
    v_mov_b32 v81, 0
    v_mov_b32 v82, 0
    v_mov_b32 v83, 0
    v_mov_b32 v84, 0
    v_mov_b32 v85, 0
    v_mov_b32 v86, 0
    v_mov_b32 v87, 0
    v_mov_b32 v88, 0
    v_mov_b32 v89, 0
    v_mov_b32 v90, 0
    v_mov_b32 v91, 0
    v_mov_b32 v92, 0
    v_mov_b32 v93, 0
    v_mov_b32 v94, 0
    v_mov_b32 v95, 0
    v_mov_b32 v96, 0
    v_mov_b32 v97, 0
    v_mov_b32 v98, 0
    v_mov_b32 v99, 0
    v_mov_b32 v100, 0
    v_mov_b32 v101, 0
    v_mov_b32 v102, 0
    v_mov_b32 v103, 0
    v_mov_b32 v104, 0
    v_mov_b32 v105, 0
    v_mov_b32 v106, 0
    v_mov_b32 v107, 0
    v_mov_b32 v108, 0
    v_mov_b32 v109, 0
    v_mov_b32 v110, 0
    v_mov_b32 v111, 0
    v_mov_b32 v11, 0
    s_mov_b32 s64, 0
    s_mov_b32 s66, 4294934528
    v_mov_b32 v152, 0
    v_mov_b32 v153, 0
    v_mov_b32 v154, 0
    v_mov_b32 v155, 0
    v_mov_b32 v156, 0
    v_mov_b32 v157, 0
    v_mov_b32 v158, 0
    v_mov_b32 v159, 0
    v_mov_b32 v160, 0
    v_mov_b32 v161, 0
    v_mov_b32 v162, 0
    v_mov_b32 v163, 0
    s_mov_b32 s61, 0
    s_mov_b32 s62, 0x4000
    s_mov_b32 s64, 0
    s_mov_b32 s67, 0
    s_mov_b32 s68, 4294917888
    s_mov_b32 s70, 2
    s_mov_b32 s71, 0
L_B_W20:
    ds_read_b32 v9, v8
    s_waitcnt lgkmcnt(0)
    v_cmp_gt_u32 vcc, 1, v9
    s_cbranch_vccz L_B_W20_ok
    s_add_u32 s71, s71, 1
    s_cmp_lt_u32 s71, 200000
    s_cbranch_scc0 L_B_W20_ok
    s_sleep 1
    s_branch L_B_W20
L_B_W20_ok:
    ds_read_b128 v[112:115], v2 offset:0
    ds_read_b64_tr_b16 v[120:121], v6 offset:0
    ds_read_b64_tr_b16 v[122:123], v6 offset:768
    ds_read_b64_tr_b16 v[124:125], v6 offset:32
    ds_read_b64_tr_b16 v[126:127], v6 offset:800
    ds_read_b64_tr_b16 v[128:129], v6 offset:64
    ds_read_b64_tr_b16 v[130:131], v6 offset:832
    ds_read_b128 v[116:119], v2 offset:4096
    v_add_u32 v2, s62, v2
    ds_read_b128 v[132:135], v3 offset:0
    ds_read_b64_tr_b16 v[140:141], v6 offset:3072
    ds_read_b64_tr_b16 v[142:143], v6 offset:3840
    ds_read_b64_tr_b16 v[144:145], v6 offset:3104
    ds_read_b64_tr_b16 v[146:147], v6 offset:3872
    ds_read_b64_tr_b16 v[148:149], v6 offset:3136
    ds_read_b64_tr_b16 v[150:151], v6 offset:3904
    ds_read_b128 v[136:139], v3 offset:4096
    v_add_u32 v3, s62, v3
    s_add_u32 s67, s67, 1
    s_cmp_eq_u32 s67, 5
    s_cselect_b32 s63, s68, 12352
    s_cselect_b32 s67, 0, s67
    v_add_u32 v6, s63, v6
    ds_read_b32 v9, v8
    s_waitcnt lgkmcnt(0)
L_B_LOOP:
    s_waitcnt lgkmcnt(14)
    v_mfma_f32_32x32x16_bf16 v[16:31], v[120:123], v[112:115], v[16:31]
    s_waitcnt lgkmcnt(12)
    v_mfma_f32_32x32x16_bf16 v[32:47], v[124:127], v[112:115], v[32:47]
    s_waitcnt lgkmcnt(10)
    v_mfma_f32_32x32x16_bf16 v[48:63], v[128:131], v[112:115], v[48:63]
    v_cmp_gt_u32 vcc, s70, v9
    s_cbranch_vccnz L_B_LOOP_S0
L_B_LOOP_B0:
    ds_read_b32 v9, v8
    s_add_u32 s70, s70, 1
    s_min_u32 s70, s70, 20
    s_cmp_eq_u32 s29, 0
    s_cbranch_scc0 L_B_LOOP_C0
    v_mfma_f32_16x16x32_bf16 v[152:155], v[12:15], v[120:123], v[152:155]
    v_mfma_f32_16x16x32_bf16 v[156:159], v[12:15], v[124:127], v[156:159]
    v_mfma_f32_16x16x32_bf16 v[160:163], v[12:15], v[128:131], v[160:163]
L_B_LOOP_C0:
    ds_read_b128 v[112:115], v4 offset:0
    s_waitcnt lgkmcnt(11)
    v_mfma_f32_32x32x16_bf16 v[64:79], v[120:123], v[116:119], v[64:79]
    ds_read_b64_tr_b16 v[120:121], v6 offset:0
    ds_read_b64_tr_b16 v[122:123], v6 offset:768
    v_mfma_f32_32x32x16_bf16 v[80:95], v[124:127], v[116:119], v[80:95]
    ds_read_b64_tr_b16 v[124:125], v6 offset:32
    ds_read_b64_tr_b16 v[126:127], v6 offset:800
    v_mfma_f32_32x32x16_bf16 v[96:111], v[128:131], v[116:119], v[96:111]
    ds_read_b64_tr_b16 v[128:129], v6 offset:64
    ds_read_b64_tr_b16 v[130:131], v6 offset:832
    ds_read_b128 v[116:119], v4 offset:4096
    v_add_u32 v4, s62, v4
    s_waitcnt lgkmcnt(14)
    v_mfma_f32_32x32x16_bf16 v[16:31], v[140:143], v[132:135], v[16:31]
    s_waitcnt lgkmcnt(12)
    v_mfma_f32_32x32x16_bf16 v[32:47], v[144:147], v[132:135], v[32:47]
    s_waitcnt lgkmcnt(10)
    v_mfma_f32_32x32x16_bf16 v[48:63], v[148:151], v[132:135], v[48:63]
    s_cmp_eq_u32 s29, 1
    s_cbranch_scc0 L_B_LOOP_C1
    v_mfma_f32_16x16x32_bf16 v[152:155], v[12:15], v[140:143], v[152:155]
    v_mfma_f32_16x16x32_bf16 v[156:159], v[12:15], v[144:147], v[156:159]
    v_mfma_f32_16x16x32_bf16 v[160:163], v[12:15], v[148:151], v[160:163]
L_B_LOOP_C1:
    ds_read_b128 v[132:135], v5 offset:0
    s_waitcnt lgkmcnt(10)
    v_add_u32 v11, 1, v11
    ds_write_b32 v10, v11
    v_mfma_f32_32x32x16_bf16 v[64:79], v[140:143], v[136:139], v[64:79]
    ds_read_b64_tr_b16 v[140:141], v6 offset:3072
    ds_read_b64_tr_b16 v[142:143], v6 offset:3840
    v_mfma_f32_32x32x16_bf16 v[80:95], v[144:147], v[136:139], v[80:95]
    ds_read_b64_tr_b16 v[144:145], v6 offset:3104
    ds_read_b64_tr_b16 v[146:147], v6 offset:3872
    v_mfma_f32_32x32x16_bf16 v[96:111], v[148:151], v[136:139], v[96:111]
    ds_read_b64_tr_b16 v[148:149], v6 offset:3136
    ds_read_b64_tr_b16 v[150:151], v6 offset:3904
    ds_read_b128 v[136:139], v5 offset:4096
    v_add_u32 v5, s62, v5
    s_add_u32 s67, s67, 1
    s_cmp_eq_u32 s67, 5
    s_cselect_b32 s63, s68, 12352
    s_cselect_b32 s67, 0, s67
    v_add_u32 v6, s63, v6
    s_add_u32 s64, s64, 1
    s_cmp_eq_u32 s64, 3
    s_cselect_b32 s64, 0, s64
    s_cmp_eq_u32 s64, 2
    s_cselect_b32 s62, s66, 0x4000
    s_waitcnt lgkmcnt(14)
    v_mfma_f32_32x32x16_bf16 v[16:31], v[120:123], v[112:115], v[16:31]
    s_waitcnt lgkmcnt(12)
    v_mfma_f32_32x32x16_bf16 v[32:47], v[124:127], v[112:115], v[32:47]
    s_waitcnt lgkmcnt(10)
    v_mfma_f32_32x32x16_bf16 v[48:63], v[128:131], v[112:115], v[48:63]
    v_cmp_gt_u32 vcc, s70, v9
    s_cbranch_vccnz L_B_LOOP_S2
L_B_LOOP_B2:
    ds_read_b32 v9, v8
    s_add_u32 s70, s70, 1
    s_min_u32 s70, s70, 20
    s_cmp_eq_u32 s29, 0
    s_cbranch_scc0 L_B_LOOP_C2
    v_mfma_f32_16x16x32_bf16 v[152:155], v[12:15], v[120:123], v[152:155]
    v_mfma_f32_16x16x32_bf16 v[156:159], v[12:15], v[124:127], v[156:159]
    v_mfma_f32_16x16x32_bf16 v[160:163], v[12:15], v[128:131], v[160:163]
L_B_LOOP_C2:
    ds_read_b128 v[112:115], v2 offset:0
    s_waitcnt lgkmcnt(11)
    v_mfma_f32_32x32x16_bf16 v[64:79], v[120:123], v[116:119], v[64:79]
    ds_read_b64_tr_b16 v[120:121], v6 offset:0
    ds_read_b64_tr_b16 v[122:123], v6 offset:768
    v_mfma_f32_32x32x16_bf16 v[80:95], v[124:127], v[116:119], v[80:95]
    ds_read_b64_tr_b16 v[124:125], v6 offset:32
    ds_read_b64_tr_b16 v[126:127], v6 offset:800
    v_mfma_f32_32x32x16_bf16 v[96:111], v[128:131], v[116:119], v[96:111]
    ds_read_b64_tr_b16 v[128:129], v6 offset:64
    ds_read_b64_tr_b16 v[130:131], v6 offset:832
    ds_read_b128 v[116:119], v2 offset:4096
    v_add_u32 v2, s62, v2
    s_waitcnt lgkmcnt(14)
    v_mfma_f32_32x32x16_bf16 v[16:31], v[140:143], v[132:135], v[16:31]
    s_waitcnt lgkmcnt(12)
    v_mfma_f32_32x32x16_bf16 v[32:47], v[144:147], v[132:135], v[32:47]
    s_waitcnt lgkmcnt(10)
    v_mfma_f32_32x32x16_bf16 v[48:63], v[148:151], v[132:135], v[48:63]
    s_cmp_eq_u32 s29, 1
    s_cbranch_scc0 L_B_LOOP_C3
    v_mfma_f32_16x16x32_bf16 v[152:155], v[12:15], v[140:143], v[152:155]
    v_mfma_f32_16x16x32_bf16 v[156:159], v[12:15], v[144:147], v[156:159]
    v_mfma_f32_16x16x32_bf16 v[160:163], v[12:15], v[148:151], v[160:163]
L_B_LOOP_C3:
    ds_read_b128 v[132:135], v3 offset:0
    s_waitcnt lgkmcnt(10)
    v_add_u32 v11, 1, v11
    ds_write_b32 v10, v11
    v_mfma_f32_32x32x16_bf16 v[64:79], v[140:143], v[136:139], v[64:79]
    ds_read_b64_tr_b16 v[140:141], v6 offset:3072
    ds_read_b64_tr_b16 v[142:143], v6 offset:3840
    v_mfma_f32_32x32x16_bf16 v[80:95], v[144:147], v[136:139], v[80:95]
    ds_read_b64_tr_b16 v[144:145], v6 offset:3104
    ds_read_b64_tr_b16 v[146:147], v6 offset:3872
    v_mfma_f32_32x32x16_bf16 v[96:111], v[148:151], v[136:139], v[96:111]
    ds_read_b64_tr_b16 v[148:149], v6 offset:3136
    ds_read_b64_tr_b16 v[150:151], v6 offset:3904
    ds_read_b128 v[136:139], v3 offset:4096
    v_add_u32 v3, s62, v3
    s_add_u32 s67, s67, 1
    s_cmp_eq_u32 s67, 5
    s_cselect_b32 s63, s68, 12352
    s_cselect_b32 s67, 0, s67
    v_add_u32 v6, s63, v6
    s_add_u32 s61, s61, 1
    s_cmp_lt_u32 s61, 10
    s_cbranch_scc1 L_B_LOOP
    s_branch L_B_LOOPD
L_B_LOOP_S0:
    s_mov_b32 s71, 0
L_B_LOOP_SL0:
    ds_read_b32 v9, v8
    s_waitcnt lgkmcnt(0)
    v_cmp_gt_u32 vcc, s70, v9
    s_cbranch_vccz L_B_LOOP_B0
    s_add_u32 s71, s71, 1
    s_cmp_lt_u32 s71, 200000
    s_cbranch_scc1 L_B_LOOP_SL0
    s_branch L_B_LOOP_B0
L_B_LOOP_S2:
    s_mov_b32 s71, 0
L_B_LOOP_SL2:
    ds_read_b32 v9, v8
    s_waitcnt lgkmcnt(0)
    v_cmp_gt_u32 vcc, s70, v9
    s_cbranch_vccz L_B_LOOP_B2
    s_add_u32 s71, s71, 1
    s_cmp_lt_u32 s71, 200000
    s_cbranch_scc1 L_B_LOOP_SL2
    s_branch L_B_LOOP_B2
L_B_LOOPD:
    s_nop 7
    s_waitcnt lgkmcnt(0)
    s_lshl_b32 s52, s30, 1
    s_add_u32 s52, s52, s29
    s_mul_i32 s52, s52, 384
    s_add_u32 s52, s52, 155008
    v_lshlrev_b32 v2, 2, v0
    v_add_u32 v2, s52, v2
    s_mov_b64 exec, 0xffff
    ds_write2_b32 v2, v152, v153 offset0:0 offset1:16
    ds_write2_b32 v2, v156, v157 offset0:32 offset1:48
    ds_write2_b32 v2, v160, v161 offset0:64 offset1:80
    s_mov_b64 exec, -1
    s_waitcnt lgkmcnt(0)
    v_mov_b32 v2, 156596
    v_mov_b32 v3, 1
    s_mov_b64 exec, 1
    ds_add_u32 v2, v3
    s_mov_b64 exec, -1
    v_mov_b32 v8, 156596
    s_mov_b32 s71, 0
L_B_TAB:
    ds_read_b32 v9, v8
    s_waitcnt lgkmcnt(0)
    v_cmp_gt_u32 vcc, 8, v9
    s_cbranch_vccz L_B_TAB_ok
    s_add_u32 s71, s71, 1
    s_cmp_lt_u32 s71, 200000
    s_cbranch_scc0 L_B_TAB_ok
    s_sleep 1
    s_branch L_B_TAB
L_B_TAB_ok:
    v_lshlrev_b32 v2, 3, v0
    s_lshl_b32 s52, s29, 10
    s_add_u32 s52, s52, 151936
    v_add_u32 v3, s52, v2
    ds_read_b64 v[112:113], v3
    ds_read_b64 v[116:117], v3 offset:512
    v_mov_b32 v114, 0
    v_mov_b32 v115, 0
    v_mov_b32 v118, 0
    v_mov_b32 v119, 0
    s_mul_i32 s52, s30, 768
    s_add_u32 s52, s52, 155008
    v_and_b32 v3, 31, v0
    v_lshlrev_b32 v3, 2, v3
    v_add_u32 v3, s52, v3
    ds_read_b32 v120, v3 offset:0
    ds_read_b32 v121, v3 offset:384
    ds_read_b32 v124, v3 offset:128
    ds_read_b32 v125, v3 offset:512
    ds_read_b32 v128, v3 offset:256
    ds_read_b32 v129, v3 offset:640
    v_cmp_gt_u32 vcc, 32, v0
    s_waitcnt lgkmcnt(0)
    v_add_f32 v122, v120, v121
    v_cndmask_b32 v122, 0, v122, vcc
    v_cvt_pk_bf16_f32 v120, v122, v122
    v_and_b32 v123, 0xffff0000, v120
    v_sub_f32 v123, v122, v123
    v_cvt_pk_bf16_f32 v121, v123, v123
    v_mov_b32 v122, 0
    v_mov_b32 v123, 0
    v_add_f32 v126, v124, v125
    v_cndmask_b32 v126, 0, v126, vcc
    v_cvt_pk_bf16_f32 v124, v126, v126
    v_and_b32 v127, 0xffff0000, v124
    v_sub_f32 v127, v126, v127
    v_cvt_pk_bf16_f32 v125, v127, v127
    v_mov_b32 v126, 0
    v_mov_b32 v127, 0
    v_add_f32 v130, v128, v129
    v_cndmask_b32 v130, 0, v130, vcc
    v_cvt_pk_bf16_f32 v128, v130, v130
    v_and_b32 v131, 0xffff0000, v128
    v_sub_f32 v131, v130, v131
    v_cvt_pk_bf16_f32 v129, v131, v131
    v_mov_b32 v130, 0
    v_mov_b32 v131, 0
    v_and_b32 v4, 31, v0
    v_lshrrev_b32 v5, 5, v0
    s_lshl_b32 s52, s29, 8
    s_add_u32 s52, s52, 157440
    v_lshlrev_b32 v3, 2, v4
    v_add_u32 v3, s52, v3
    ds_read_b32 v132, v3
    ds_read_b32 v133, v3 offset:128
    ds_read_b32 v134, v3 offset:512
    ds_read_b32 v135, v3 offset:640
    s_waitcnt lgkmcnt(0)
    v_mfma_f32_32x32x16_bf16 v[16:31], v[120:123], v[112:115], v[16:31]
    v_mfma_f32_32x32x16_bf16 v[32:47], v[124:127], v[112:115], v[32:47]
    v_mfma_f32_32x32x16_bf16 v[48:63], v[128:131], v[112:115], v[48:63]
    v_mfma_f32_32x32x16_bf16 v[64:79], v[120:123], v[116:119], v[64:79]
    v_mfma_f32_32x32x16_bf16 v[80:95], v[124:127], v[116:119], v[80:95]
    v_mfma_f32_32x32x16_bf16 v[96:111], v[128:131], v[116:119], v[96:111]
    v_bfe_u32 v6, v0, 4, 1
    v_mul_u32_u24 v6, 49152, v6
    v_lshl_add_u32 v6, v5, 8, v6
    v_and_b32 v7, 15, v0
    v_lshl_add_u32 v6, v7, 4, v6
    s_lshl_b32 s52, s25, 3
    s_lshl_b32 s53, s29, 2
    s_add_u32 s52, s52, s53
    s_mul_i32 s52, s52, 49152
    s_mul_i32 s53, s26, 6
    s_mul_i32 s54, s30, 3
    s_add_u32 s53, s53, s54
    s_lshl_b32 s53, s53, 9
    s_add_u32 s52, s52, s53
    s_add_u32 s56, s52, 7995392
    s_nop 4
    v_mul_f32 v136, v132, v16
    v_mul_f32 v137, v132, v17
    v_mul_f32 v138, v132, v18
    v_mul_f32 v139, v132, v19
    v_mul_f32 v140, v132, v20
    v_mul_f32 v141, v132, v21
    v_mul_f32 v142, v132, v22
    v_mul_f32 v143, v132, v23
    v_exp_f32 v136, v136
    v_exp_f32 v137, v137
    v_exp_f32 v138, v138
    v_exp_f32 v139, v139
    v_exp_f32 v140, v140
    v_exp_f32 v141, v141
    v_exp_f32 v142, v142
    v_exp_f32 v143, v143
    v_mul_f32 v16, v16, v24
    v_mul_f32 v17, v17, v25
    v_mul_f32 v18, v18, v26
    v_mul_f32 v19, v19, v27
    v_mul_f32 v20, v20, v28
    v_mul_f32 v21, v21, v29
    v_mul_f32 v22, v22, v30
    v_mul_f32 v23, v23, v31
    v_fma_f32 v136, v136, v134, v134
    v_fma_f32 v137, v137, v134, v134
    v_fma_f32 v138, v138, v134, v134
    v_fma_f32 v139, v139, v134, v134
    v_fma_f32 v140, v140, v134, v134
    v_fma_f32 v141, v141, v134, v134
    v_fma_f32 v142, v142, v134, v134
    v_fma_f32 v143, v143, v134, v134
    v_rcp_f32 v136, v136
    v_rcp_f32 v137, v137
    v_rcp_f32 v138, v138
    v_rcp_f32 v139, v139
    v_rcp_f32 v140, v140
    v_rcp_f32 v141, v141
    v_rcp_f32 v142, v142
    v_rcp_f32 v143, v143
    s_add_u32 s52, s56, 0
    v_mul_f32 v16, v16, v136
    v_mul_f32 v17, v17, v137
    v_mul_f32 v18, v18, v138
    v_mul_f32 v19, v19, v139
    v_mul_f32 v20, v20, v140
    v_mul_f32 v21, v21, v141
    v_mul_f32 v22, v22, v142
    v_mul_f32 v23, v23, v143
    v_cvt_pk_bf16_f32 v144, v16, v17
    v_cvt_pk_bf16_f32 v145, v18, v19
    v_cvt_pk_bf16_f32 v146, v20, v21
    v_cvt_pk_bf16_f32 v147, v22, v23
    buffer_store_dwordx4 v[144:147], v6, s[32:35], s52 offen sc1
    v_mul_f32 v148, v132, v32
    v_mul_f32 v149, v132, v33
    v_mul_f32 v150, v132, v34
    v_mul_f32 v151, v132, v35
    v_mul_f32 v152, v132, v36
    v_mul_f32 v153, v132, v37
    v_mul_f32 v154, v132, v38
    v_mul_f32 v155, v132, v39
    v_exp_f32 v148, v148
    v_exp_f32 v149, v149
    v_exp_f32 v150, v150
    v_exp_f32 v151, v151
    v_exp_f32 v152, v152
    v_exp_f32 v153, v153
    v_exp_f32 v154, v154
    v_exp_f32 v155, v155
    v_mul_f32 v32, v32, v40
    v_mul_f32 v33, v33, v41
    v_mul_f32 v34, v34, v42
    v_mul_f32 v35, v35, v43
    v_mul_f32 v36, v36, v44
    v_mul_f32 v37, v37, v45
    v_mul_f32 v38, v38, v46
    v_mul_f32 v39, v39, v47
    v_fma_f32 v148, v148, v134, v134
    v_fma_f32 v149, v149, v134, v134
    v_fma_f32 v150, v150, v134, v134
    v_fma_f32 v151, v151, v134, v134
    v_fma_f32 v152, v152, v134, v134
    v_fma_f32 v153, v153, v134, v134
    v_fma_f32 v154, v154, v134, v134
    v_fma_f32 v155, v155, v134, v134
    v_rcp_f32 v148, v148
    v_rcp_f32 v149, v149
    v_rcp_f32 v150, v150
    v_rcp_f32 v151, v151
    v_rcp_f32 v152, v152
    v_rcp_f32 v153, v153
    v_rcp_f32 v154, v154
    v_rcp_f32 v155, v155
    s_add_u32 s52, s56, 512
    v_mul_f32 v32, v32, v148
    v_mul_f32 v33, v33, v149
    v_mul_f32 v34, v34, v150
    v_mul_f32 v35, v35, v151
    v_mul_f32 v36, v36, v152
    v_mul_f32 v37, v37, v153
    v_mul_f32 v38, v38, v154
    v_mul_f32 v39, v39, v155
    v_cvt_pk_bf16_f32 v156, v32, v33
    v_cvt_pk_bf16_f32 v157, v34, v35
    v_cvt_pk_bf16_f32 v158, v36, v37
    v_cvt_pk_bf16_f32 v159, v38, v39
    buffer_store_dwordx4 v[156:159], v6, s[32:35], s52 offen sc1
    v_mul_f32 v136, v132, v48
    v_mul_f32 v137, v132, v49
    v_mul_f32 v138, v132, v50
    v_mul_f32 v139, v132, v51
    v_mul_f32 v140, v132, v52
    v_mul_f32 v141, v132, v53
    v_mul_f32 v142, v132, v54
    v_mul_f32 v143, v132, v55
    v_exp_f32 v136, v136
    v_exp_f32 v137, v137
    v_exp_f32 v138, v138
    v_exp_f32 v139, v139
    v_exp_f32 v140, v140
    v_exp_f32 v141, v141
    v_exp_f32 v142, v142
    v_exp_f32 v143, v143
    v_mul_f32 v48, v48, v56
    v_mul_f32 v49, v49, v57
    v_mul_f32 v50, v50, v58
    v_mul_f32 v51, v51, v59
    v_mul_f32 v52, v52, v60
    v_mul_f32 v53, v53, v61
    v_mul_f32 v54, v54, v62
    v_mul_f32 v55, v55, v63
    v_fma_f32 v136, v136, v134, v134
    v_fma_f32 v137, v137, v134, v134
    v_fma_f32 v138, v138, v134, v134
    v_fma_f32 v139, v139, v134, v134
    v_fma_f32 v140, v140, v134, v134
    v_fma_f32 v141, v141, v134, v134
    v_fma_f32 v142, v142, v134, v134
    v_fma_f32 v143, v143, v134, v134
    v_rcp_f32 v136, v136
    v_rcp_f32 v137, v137
    v_rcp_f32 v138, v138
    v_rcp_f32 v139, v139
    v_rcp_f32 v140, v140
    v_rcp_f32 v141, v141
    v_rcp_f32 v142, v142
    v_rcp_f32 v143, v143
    s_add_u32 s52, s56, 1024
    v_mul_f32 v48, v48, v136
    v_mul_f32 v49, v49, v137
    v_mul_f32 v50, v50, v138
    v_mul_f32 v51, v51, v139
    v_mul_f32 v52, v52, v140
    v_mul_f32 v53, v53, v141
    v_mul_f32 v54, v54, v142
    v_mul_f32 v55, v55, v143
    v_cvt_pk_bf16_f32 v144, v48, v49
    v_cvt_pk_bf16_f32 v145, v50, v51
    v_cvt_pk_bf16_f32 v146, v52, v53
    v_cvt_pk_bf16_f32 v147, v54, v55
    buffer_store_dwordx4 v[144:147], v6, s[32:35], s52 offen sc1
    v_mul_f32 v148, v133, v64
    v_mul_f32 v149, v133, v65
    v_mul_f32 v150, v133, v66
    v_mul_f32 v151, v133, v67
    v_mul_f32 v152, v133, v68
    v_mul_f32 v153, v133, v69
    v_mul_f32 v154, v133, v70
    v_mul_f32 v155, v133, v71
    v_exp_f32 v148, v148
    v_exp_f32 v149, v149
    v_exp_f32 v150, v150
    v_exp_f32 v151, v151
    v_exp_f32 v152, v152
    v_exp_f32 v153, v153
    v_exp_f32 v154, v154
    v_exp_f32 v155, v155
    v_mul_f32 v64, v64, v72
    v_mul_f32 v65, v65, v73
    v_mul_f32 v66, v66, v74
    v_mul_f32 v67, v67, v75
    v_mul_f32 v68, v68, v76
    v_mul_f32 v69, v69, v77
    v_mul_f32 v70, v70, v78
    v_mul_f32 v71, v71, v79
    v_fma_f32 v148, v148, v135, v135
    v_fma_f32 v149, v149, v135, v135
    v_fma_f32 v150, v150, v135, v135
    v_fma_f32 v151, v151, v135, v135
    v_fma_f32 v152, v152, v135, v135
    v_fma_f32 v153, v153, v135, v135
    v_fma_f32 v154, v154, v135, v135
    v_fma_f32 v155, v155, v135, v135
    v_rcp_f32 v148, v148
    v_rcp_f32 v149, v149
    v_rcp_f32 v150, v150
    v_rcp_f32 v151, v151
    v_rcp_f32 v152, v152
    v_rcp_f32 v153, v153
    v_rcp_f32 v154, v154
    v_rcp_f32 v155, v155
    s_add_u32 s52, s56, 98304
    v_mul_f32 v64, v64, v148
    v_mul_f32 v65, v65, v149
    v_mul_f32 v66, v66, v150
    v_mul_f32 v67, v67, v151
    v_mul_f32 v68, v68, v152
    v_mul_f32 v69, v69, v153
    v_mul_f32 v70, v70, v154
    v_mul_f32 v71, v71, v155
    v_cvt_pk_bf16_f32 v156, v64, v65
    v_cvt_pk_bf16_f32 v157, v66, v67
    v_cvt_pk_bf16_f32 v158, v68, v69
    v_cvt_pk_bf16_f32 v159, v70, v71
    buffer_store_dwordx4 v[156:159], v6, s[32:35], s52 offen sc1
    v_mul_f32 v136, v133, v80
    v_mul_f32 v137, v133, v81
    v_mul_f32 v138, v133, v82
    v_mul_f32 v139, v133, v83
    v_mul_f32 v140, v133, v84
    v_mul_f32 v141, v133, v85
    v_mul_f32 v142, v133, v86
    v_mul_f32 v143, v133, v87
    v_exp_f32 v136, v136
    v_exp_f32 v137, v137
    v_exp_f32 v138, v138
    v_exp_f32 v139, v139
    v_exp_f32 v140, v140
    v_exp_f32 v141, v141
    v_exp_f32 v142, v142
    v_exp_f32 v143, v143
    v_mul_f32 v80, v80, v88
    v_mul_f32 v81, v81, v89
    v_mul_f32 v82, v82, v90
    v_mul_f32 v83, v83, v91
    v_mul_f32 v84, v84, v92
    v_mul_f32 v85, v85, v93
    v_mul_f32 v86, v86, v94
    v_mul_f32 v87, v87, v95
    v_fma_f32 v136, v136, v135, v135
    v_fma_f32 v137, v137, v135, v135
    v_fma_f32 v138, v138, v135, v135
    v_fma_f32 v139, v139, v135, v135
    v_fma_f32 v140, v140, v135, v135
    v_fma_f32 v141, v141, v135, v135
    v_fma_f32 v142, v142, v135, v135
    v_fma_f32 v143, v143, v135, v135
    v_rcp_f32 v136, v136
    v_rcp_f32 v137, v137
    v_rcp_f32 v138, v138
    v_rcp_f32 v139, v139
    v_rcp_f32 v140, v140
    v_rcp_f32 v141, v141
    v_rcp_f32 v142, v142
    v_rcp_f32 v143, v143
    s_add_u32 s52, s56, 98816
    v_mul_f32 v80, v80, v136
    v_mul_f32 v81, v81, v137
    v_mul_f32 v82, v82, v138
    v_mul_f32 v83, v83, v139
    v_mul_f32 v84, v84, v140
    v_mul_f32 v85, v85, v141
    v_mul_f32 v86, v86, v142
    v_mul_f32 v87, v87, v143
    v_cvt_pk_bf16_f32 v144, v80, v81
    v_cvt_pk_bf16_f32 v145, v82, v83
    v_cvt_pk_bf16_f32 v146, v84, v85
    v_cvt_pk_bf16_f32 v147, v86, v87
    buffer_store_dwordx4 v[144:147], v6, s[32:35], s52 offen sc1
    v_mul_f32 v148, v133, v96
    v_mul_f32 v149, v133, v97
    v_mul_f32 v150, v133, v98
    v_mul_f32 v151, v133, v99
    v_mul_f32 v152, v133, v100
    v_mul_f32 v153, v133, v101
    v_mul_f32 v154, v133, v102
    v_mul_f32 v155, v133, v103
    v_exp_f32 v148, v148
    v_exp_f32 v149, v149
    v_exp_f32 v150, v150
    v_exp_f32 v151, v151
    v_exp_f32 v152, v152
    v_exp_f32 v153, v153
    v_exp_f32 v154, v154
    v_exp_f32 v155, v155
    v_mul_f32 v96, v96, v104
    v_mul_f32 v97, v97, v105
    v_mul_f32 v98, v98, v106
    v_mul_f32 v99, v99, v107
    v_mul_f32 v100, v100, v108
    v_mul_f32 v101, v101, v109
    v_mul_f32 v102, v102, v110
    v_mul_f32 v103, v103, v111
    v_fma_f32 v148, v148, v135, v135
    v_fma_f32 v149, v149, v135, v135
    v_fma_f32 v150, v150, v135, v135
    v_fma_f32 v151, v151, v135, v135
    v_fma_f32 v152, v152, v135, v135
    v_fma_f32 v153, v153, v135, v135
    v_fma_f32 v154, v154, v135, v135
    v_fma_f32 v155, v155, v135, v135
    v_rcp_f32 v148, v148
    v_rcp_f32 v149, v149
    v_rcp_f32 v150, v150
    v_rcp_f32 v151, v151
    v_rcp_f32 v152, v152
    v_rcp_f32 v153, v153
    v_rcp_f32 v154, v154
    v_rcp_f32 v155, v155
    s_add_u32 s52, s56, 99328
    v_mul_f32 v96, v96, v148
    v_mul_f32 v97, v97, v149
    v_mul_f32 v98, v98, v150
    v_mul_f32 v99, v99, v151
    v_mul_f32 v100, v100, v152
    v_mul_f32 v101, v101, v153
    v_mul_f32 v102, v102, v154
    v_mul_f32 v103, v103, v155
    v_cvt_pk_bf16_f32 v156, v96, v97
    v_cvt_pk_bf16_f32 v157, v98, v99
    v_cvt_pk_bf16_f32 v158, v100, v101
    v_cvt_pk_bf16_f32 v159, v102, v103
    buffer_store_dwordx4 v[156:159], v6, s[32:35], s52 offen sc1
L_END:
    s_endpgm
.globl attn_kernel
.p2align 8
.type attn_kernel,@function
attn_kernel:
    s_cmp_ge_u32 s2, 256
    s_cbranch_scc1 L_K2_END
    s_load_dwordx4 s[4:7], s[0:1], 0
    s_load_dwordx4 s[16:19], s[0:1], 48
    s_load_dwordx4 s[20:23], s[0:1], 64
    v_lshrrev_b32 v1, 6, v0
    v_and_b32 v0, 63, v0
    s_nop 0
    v_readfirstlane_b32 s24, v1
    v_lshlrev_b32 v2, 2, v0
    v_add_u32 v2, 92160, v2
    v_mov_b32 v3, 0
    ds_write_b32 v2, v3
    s_and_b32 s28, s24, 3
    s_waitcnt lgkmcnt(0)
    s_mov_b32 s32, s22
    s_and_b32 s33, s23, 0xffff
    s_mov_b32 s34, 24936448
    s_mov_b32 s35, 0x00020000
    s_cmp_lt_u32 s24, 8
    s_cbranch_scc0 L_K2_P
    s_lshr_b32 s49, s24, 2
    s_mul_i32 s42, s49, 44
    s_cmp_eq_u32 s49, 0
    s_cselect_b32 s43, 11, 5
    s_and_b32 s52, s2, 7
    s_lshl_b32 s52, s52, 2
    s_bfe_u32 s53, s2, 0x20003
    s_add_u32 s40, s52, s53
    s_lshr_b32 s41, s2, 5
    s_lshr_b32 s52, s40, 1
    s_mul_i32 s52, s52, 5
    s_and_b32 s53, s40, 1
    s_mul_i32 s54, s53, 3
    s_add_u32 s54, s54, s52
    s_add_u32 s55, s52, 2
    s_mul_i32 s54, s54, 32768
    s_mul_i32 s55, s55, 32768
    s_lshl_b32 s56, s53, 3
    s_add_u32 s55, s55, s56
    s_add_u32 s54, s54, 131072
    s_add_u32 s55, s55, 131072
    v_and_b32 v10, 31, v0
    v_lshrrev_b32 v11, 5, v0
    v_lshlrev_b32 v12, 4, v10
    v_lshl_add_u32 v13, v11, 15, v12
    v_add_u32 v13, s54, v13
    v_add_u32 v14, s55, v12
    v_cmp_eq_u32 vcc, 0, v11
    v_mov_b32 v15, 0x7ff00000
    v_cndmask_b32 v14, v15, v14, vcc
    v_add_u32 v2, 2621440, v13
    v_add_u32 v3, 2621440, v14
    v_cndmask_b32 v3, v15, v3, vcc
    s_lshl_b32 s56, s41, 8
    s_lshl_b32 s57, s28, 6
    s_add_u32 s56, s56, s57
    s_lshl_b32 s57, s49, 5
    s_add_u32 s58, s56, s57
    s_xor_b32 s57, s57, 32
    s_add_u32 s59, s56, s57
    s_lshl_b32 s56, s58, 4
    s_lshl_b32 s57, s59, 4
    s_mov_b32 s51, s58
    buffer_load_dwordx4 v[80:83], v13, s[32:35], s56 offen
    buffer_load_dwordx2 v[84:85], v14, s[32:35], s56 offen
    buffer_load_dwordx4 v[88:91], v13, s[32:35], s57 offen
    buffer_load_dwordx2 v[92:93], v14, s[32:35], s57 offen
    s_mul_i32 s52, s40, 320
    s_add_u32 s52, s52, 5373952
    v_mul_u32_u24 v4, 10240, v11
    v_add_u32 v4, v4, v12
    v_add_u32 v4, s52, v4
    v_add_u32 v5, 20480, v4
    s_mov_b32 s46, 0x000fffff
    s_mov_b32 s47, 0x000fffff
    s_mov_b32 s48, 0
    v_mov_b32 v12, 0x3f803f80
    v_cndmask_b32 v13, 0, v12, vcc
    v_lshrrev_b32 v14, 16, v13
    v_cmp_eq_u32 vcc, 20, v10
    v_cndmask_b32 v12, 0, v12, vcc
    v_mov_b32 v102, v13
    v_mov_b32 v103, v14
    v_mov_b32 v104, v12
    v_mov_b32 v105, v12
    v_mov_b32 v106, v12
    v_mov_b32 v107, v12
    v_mov_b32 v108, v12
    v_mov_b32 v109, v12
    v_mov_b32 v110, v12
    v_mov_b32 v111, v12
    v_mov_b32 v118, v13
    v_mov_b32 v119, v14
    v_mov_b32 v120, v12
    v_mov_b32 v121, v12
    v_mov_b32 v122, v12
    v_mov_b32 v123, v12
    v_mov_b32 v124, v12
    v_mov_b32 v125, v12
    v_mov_b32 v126, v12
    v_mov_b32 v127, v12
    v_mov_b32 v134, v13
    v_mov_b32 v135, v14
    v_mov_b32 v136, v12
    v_mov_b32 v137, v12
    v_mov_b32 v138, v12
    v_mov_b32 v139, v12
    v_mov_b32 v140, v12
    v_mov_b32 v141, v12
    v_mov_b32 v142, v12
    v_mov_b32 v143, v12
    v_mov_b32 v150, v13
    v_mov_b32 v151, v14
    v_mov_b32 v152, v12
    v_mov_b32 v153, v12
    v_mov_b32 v154, v12
    v_mov_b32 v155, v12
    v_mov_b32 v156, v12
    v_mov_b32 v157, v12
    v_mov_b32 v158, v12
    v_mov_b32 v159, v12
    s_lshl_b32 s44, s42, 9
    s_mul_i32 s45, s42, 40960
    buffer_load_dwordx4 v[96:99], v2, s[32:35], s44 offen
    buffer_load_dwordx2 v[100:101], v3, s[32:35], s44 offen
    s_mov_b64 exec, s[46:47]
    buffer_load_dwordx4 v[104:107], v4, s[32:35], s45 offen
    buffer_load_dwordx4 v[108:111], v5, s[32:35], s45 offen
    s_mov_b64 exec, -1
    s_add_u32 s44, s44, 512
    s_add_u32 s45, s45, 40960
    buffer_load_dwordx4 v[112:115], v2, s[32:35], s44 offen
    buffer_load_dwordx2 v[116:117], v3, s[32:35], s44 offen
    s_mov_b64 exec, s[46:47]
    buffer_load_dwordx4 v[120:123], v4, s[32:35], s45 offen
    buffer_load_dwordx4 v[124:127], v5, s[32:35], s45 offen
    s_mov_b64 exec, -1
    s_add_u32 s44, s44, 512
    s_add_u32 s45, s45, 40960
    buffer_load_dwordx4 v[128:131], v2, s[32:35], s44 offen
    buffer_load_dwordx2 v[132:133], v3, s[32:35], s44 offen
    s_mov_b64 exec, s[46:47]
    buffer_load_dwordx4 v[136:139], v4, s[32:35], s45 offen
    buffer_load_dwordx4 v[140:143], v5, s[32:35], s45 offen
    s_mov_b64 exec, -1
    s_add_u32 s44, s44, 512
    s_add_u32 s45, s45, 40960
    s_barrier
    s_branch L_ATT_START2
L_ATT_START:
    s_lshl_b32 s44, s42, 9
    s_mul_i32 s45, s42, 40960
    buffer_load_dwordx4 v[96:99], v2, s[32:35], s44 offen
    buffer_load_dwordx2 v[100:101], v3, s[32:35], s44 offen
    s_mov_b64 exec, s[46:47]
    buffer_load_dwordx4 v[104:107], v4, s[32:35], s45 offen
    buffer_load_dwordx4 v[108:111], v5, s[32:35], s45 offen
    s_mov_b64 exec, -1
    s_add_u32 s44, s44, 512
    s_add_u32 s45, s45, 40960
    buffer_load_dwordx4 v[112:115], v2, s[32:35], s44 offen
    buffer_load_dwordx2 v[116:117], v3, s[32:35], s44 offen
    s_mov_b64 exec, s[46:47]
    buffer_load_dwordx4 v[120:123], v4, s[32:35], s45 offen
    buffer_load_dwordx4 v[124:127], v5, s[32:35], s45 offen
    s_mov_b64 exec, -1
    s_add_u32 s44, s44, 512
    s_add_u32 s45, s45, 40960
    buffer_load_dwordx4 v[128:131], v2, s[32:35], s44 offen
    buffer_load_dwordx2 v[132:133], v3, s[32:35], s44 offen
    s_mov_b64 exec, s[46:47]
    buffer_load_dwordx4 v[136:139], v4, s[32:35], s45 offen
    buffer_load_dwordx4 v[140:143], v5, s[32:35], s45 offen
    s_mov_b64 exec, -1
    s_add_u32 s44, s44, 512
    s_add_u32 s45, s45, 40960
L_ATT_START2:
    v_mov_b32 v86, 0
    v_mov_b32 v87, 0
    v_mov_b32 v94, 0
    v_mov_b32 v95, 0
    s_cmp_eq_u32 s48, 0
    s_cbranch_scc0 L_ATT_HAVEM
    s_waitcnt vmcnt(4)
    v_mfma_f32_32x32x16_bf16 v[48:63], v[96:99], v[80:83], 0
    v_mfma_f32_32x32x16_bf16 v[48:63], v[100:103], v[84:87], v[48:63]
    v_mfma_f32_32x32x16_bf16 v[64:79], v[112:115], v[80:83], 0
    v_mfma_f32_32x32x16_bf16 v[64:79], v[116:119], v[84:87], v[64:79]
    s_nop 7
    s_nop 7
    v_max3_f32 v6, v48, v49, v50
    v_max3_f32 v6, v6, v51, v52
    v_max3_f32 v6, v6, v53, v54
    v_max3_f32 v6, v6, v55, v56
    v_max3_f32 v6, v6, v57, v58
    v_max3_f32 v6, v6, v59, v60
    v_max3_f32 v6, v6, v61, v62
    v_max3_f32 v6, v6, v63, v64
    v_max3_f32 v6, v6, v65, v66
    v_max3_f32 v6, v6, v67, v68
    v_max3_f32 v6, v6, v69, v70
    v_max3_f32 v6, v6, v71, v72
    v_max3_f32 v6, v6, v73, v74
    v_max3_f32 v6, v6, v75, v76
    v_max3_f32 v6, v6, v77, v78
    v_max_f32 v6, v6, v79
    v_mfma_f32_32x32x16_bf16 v[48:63], v[96:99], v[88:91], 0
    v_mfma_f32_32x32x16_bf16 v[48:63], v[100:103], v[92:95], v[48:63]
    v_mfma_f32_32x32x16_bf16 v[64:79], v[112:115], v[88:91], 0
    v_mfma_f32_32x32x16_bf16 v[64:79], v[116:119], v[92:95], v[64:79]
    s_nop 7
    s_nop 7
    v_max3_f32 v7, v48, v49, v50
    v_max3_f32 v7, v7, v51, v52
    v_max3_f32 v7, v7, v53, v54
    v_max3_f32 v7, v7, v55, v56
    v_max3_f32 v7, v7, v57, v58
    v_max3_f32 v7, v7, v59, v60
    v_max3_f32 v7, v7, v61, v62
    v_max3_f32 v7, v7, v63, v64
    v_max3_f32 v7, v7, v65, v66
    v_max3_f32 v7, v7, v67, v68
    v_max3_f32 v7, v7, v69, v70
    v_max3_f32 v7, v7, v71, v72
    v_max3_f32 v7, v7, v73, v74
    v_max3_f32 v7, v7, v75, v76
    v_max3_f32 v7, v7, v77, v78
    v_max_f32 v7, v7, v79
    v_mov_b32 v160, v6
    s_nop 1
    v_permlane32_swap_b32 v6, v160
    s_nop 1
    v_max_f32 v6, v6, v160
    v_add_f32 v6, 0x42c00000, v6
    v_mov_b32 v160, v7
    s_nop 1
    v_permlane32_swap_b32 v7, v160
    s_nop 1
    v_max_f32 v7, v7, v160
    v_add_f32 v7, 0x42c00000, v7
L_ATT_HAVEM:
    v_cmp_gt_u32 vcc, 32, v0
    v_sub_f32 v160, 0, v6
    v_cvt_pk_bf16_f32 v161, v160, v160
    v_and_b32 v161, 0xffff0000, v161
    v_sub_f32 v162, v160, v161
    v_cvt_pk_bf16_f32 v163, v162, v162
    v_and_b32 v163, 0xffff0000, v163
    v_sub_f32 v164, v162, v163
    v_cvt_pk_bf16_f32 v165, v164, v164
    v_and_b32 v165, 0xffff0000, v165
    v_add_f32 v166, v163, v165
    v_add_f32 v166, v161, v166
    v_sub_f32 v6, 0, v166
    v_lshrrev_b32 v161, 16, v161
    v_or_b32 v161, v161, v163
    v_lshrrev_b32 v165, 16, v165
    v_cndmask_b32 v86, 0, v161, vcc
    v_cndmask_b32 v87, 0, v165, vcc
    v_sub_f32 v160, 0, v7
    v_cvt_pk_bf16_f32 v161, v160, v160
    v_and_b32 v161, 0xffff0000, v161
    v_sub_f32 v162, v160, v161
    v_cvt_pk_bf16_f32 v163, v162, v162
    v_and_b32 v163, 0xffff0000, v163
    v_sub_f32 v164, v162, v163
    v_cvt_pk_bf16_f32 v165, v164, v164
    v_and_b32 v165, 0xffff0000, v165
    v_add_f32 v166, v163, v165
    v_add_f32 v166, v161, v166
    v_sub_f32 v7, 0, v166
    v_lshrrev_b32 v161, 16, v161
    v_or_b32 v161, v161, v163
    v_lshrrev_b32 v165, 16, v165
    v_cndmask_b32 v94, 0, v161, vcc
    v_cndmask_b32 v95, 0, v165, vcc
    v_mov_b32 v16, 0
    v_mov_b32 v17, 0
    v_mov_b32 v18, 0
    v_mov_b32 v19, 0
    v_mov_b32 v20, 0
    v_mov_b32 v21, 0
    v_mov_b32 v22, 0
    v_mov_b32 v23, 0
    v_mov_b32 v24, 0
    v_mov_b32 v25, 0
    v_mov_b32 v26, 0
    v_mov_b32 v27, 0
    v_mov_b32 v28, 0
    v_mov_b32 v29, 0
    v_mov_b32 v30, 0
    v_mov_b32 v31, 0
    v_mov_b32 v32, 0
    v_mov_b32 v33, 0
    v_mov_b32 v34, 0
    v_mov_b32 v35, 0
    v_mov_b32 v36, 0
    v_mov_b32 v37, 0
    v_mov_b32 v38, 0
    v_mov_b32 v39, 0
    v_mov_b32 v40, 0
    v_mov_b32 v41, 0
    v_mov_b32 v42, 0
    v_mov_b32 v43, 0
    v_mov_b32 v44, 0
    v_mov_b32 v45, 0
    v_mov_b32 v46, 0
    v_mov_b32 v47, 0
    v_mov_b32 v8, 0
    v_mov_b32 v9, 0
    v_mov_b32 v10, 0
    v_mov_b32 v11, 0
    v_mov_b32 v12, 0
    v_mov_b32 v13, 0
    v_mov_b32 v14, 0
    v_mov_b32 v15, 0
    s_waitcnt vmcnt(4)
    v_mfma_f32_32x32x16_bf16 v[48:63], v[96:99], v[80:83], 0
    v_mfma_f32_32x32x16_bf16 v[48:63], v[100:103], v[84:87], v[48:63]
    s_mov_b32 s50, 0
    s_nop 7
    s_nop 3
L_ATT_LOOP:
    v_mfma_f32_32x32x16_bf16 v[64:79], v[96:99], v[88:91], 0
    v_exp_f32 v48, v48
    v_exp_f32 v49, v49
    v_exp_f32 v50, v50
    v_exp_f32 v51, v51
    v_exp_f32 v52, v52
    v_exp_f32 v53, v53
    v_mfma_f32_32x32x16_bf16 v[32:47], v[156:159], v[12:15], v[32:47]
    v_exp_f32 v54, v54
    v_exp_f32 v55, v55
    buffer_load_dwordx4 v[144:147], v2, s[32:35], s44 offen
    buffer_load_dwordx2 v[148:149], v3, s[32:35], s44 offen
    s_mov_b64 exec, s[46:47]
    buffer_load_dwordx4 v[152:155], v4, s[32:35], s45 offen
    buffer_load_dwordx4 v[156:159], v5, s[32:35], s45 offen
    s_mov_b64 exec, -1
    s_add_u32 s44, s44, 512
    s_add_u32 s45, s45, 40960
    v_cvt_pk_bf16_f32 v8, v48, v49
    v_cvt_pk_bf16_f32 v9, v50, v51
    v_cvt_pk_bf16_f32 v10, v52, v53
    v_cvt_pk_bf16_f32 v11, v54, v55
    v_mfma_f32_32x32x16_bf16 v[64:79], v[100:103], v[92:95], v[64:79]
    v_exp_f32 v56, v56
    v_exp_f32 v57, v57
    v_exp_f32 v58, v58
    v_exp_f32 v59, v59
    v_exp_f32 v60, v60
    v_exp_f32 v61, v61
    v_mfma_f32_32x32x16_bf16 v[16:31], v[104:107], v[8:11], v[16:31]
    v_exp_f32 v62, v62
    v_exp_f32 v63, v63
    v_cvt_pk_bf16_f32 v12, v56, v57
    v_cvt_pk_bf16_f32 v13, v58, v59
    v_cvt_pk_bf16_f32 v14, v60, v61
    v_cvt_pk_bf16_f32 v15, v62, v63
    s_waitcnt vmcnt(8)
    v_mfma_f32_32x32x16_bf16 v[48:63], v[112:115], v[80:83], 0
    v_exp_f32 v64, v64
    v_exp_f32 v65, v65
    v_exp_f32 v66, v66
    v_exp_f32 v67, v67
    v_exp_f32 v68, v68
    v_exp_f32 v69, v69
    v_mfma_f32_32x32x16_bf16 v[16:31], v[108:111], v[12:15], v[16:31]
    v_exp_f32 v70, v70
    v_exp_f32 v71, v71
    v_cvt_pk_bf16_f32 v8, v64, v65
    v_cvt_pk_bf16_f32 v9, v66, v67
    v_cvt_pk_bf16_f32 v10, v68, v69
    v_cvt_pk_bf16_f32 v11, v70, v71
    v_mfma_f32_32x32x16_bf16 v[48:63], v[116:119], v[84:87], v[48:63]
    v_exp_f32 v72, v72
    v_exp_f32 v73, v73
    v_exp_f32 v74, v74
    v_exp_f32 v75, v75
    v_exp_f32 v76, v76
    v_exp_f32 v77, v77
    v_mfma_f32_32x32x16_bf16 v[32:47], v[104:107], v[8:11], v[32:47]
    v_exp_f32 v78, v78
    v_exp_f32 v79, v79
    v_cvt_pk_bf16_f32 v12, v72, v73
    v_cvt_pk_bf16_f32 v13, v74, v75
    v_cvt_pk_bf16_f32 v14, v76, v77
    v_cvt_pk_bf16_f32 v15, v78, v79
    v_mfma_f32_32x32x16_bf16 v[64:79], v[112:115], v[88:91], 0
    v_exp_f32 v48, v48
    v_exp_f32 v49, v49
    v_exp_f32 v50, v50
    v_exp_f32 v51, v51
    v_exp_f32 v52, v52
    v_exp_f32 v53, v53
    v_mfma_f32_32x32x16_bf16 v[32:47], v[108:111], v[12:15], v[32:47]
    v_exp_f32 v54, v54
    v_exp_f32 v55, v55
    buffer_load_dwordx4 v[96:99], v2, s[32:35], s44 offen
    buffer_load_dwordx2 v[100:101], v3, s[32:35], s44 offen
    s_mov_b64 exec, s[46:47]
    buffer_load_dwordx4 v[104:107], v4, s[32:35], s45 offen
    buffer_load_dwordx4 v[108:111], v5, s[32:35], s45 offen
    s_mov_b64 exec, -1
    s_add_u32 s44, s44, 512
    s_add_u32 s45, s45, 40960
    v_cvt_pk_bf16_f32 v8, v48, v49
    v_cvt_pk_bf16_f32 v9, v50, v51
    v_cvt_pk_bf16_f32 v10, v52, v53
    v_cvt_pk_bf16_f32 v11, v54, v55
    v_mfma_f32_32x32x16_bf16 v[64:79], v[116:119], v[92:95], v[64:79]
    v_exp_f32 v56, v56
    v_exp_f32 v57, v57
    v_exp_f32 v58, v58
    v_exp_f32 v59, v59
    v_exp_f32 v60, v60
    v_exp_f32 v61, v61
    v_mfma_f32_32x32x16_bf16 v[16:31], v[120:123], v[8:11], v[16:31]
    v_exp_f32 v62, v62
    v_exp_f32 v63, v63
    v_cvt_pk_bf16_f32 v12, v56, v57
    v_cvt_pk_bf16_f32 v13, v58, v59
    v_cvt_pk_bf16_f32 v14, v60, v61
    v_cvt_pk_bf16_f32 v15, v62, v63
    s_waitcnt vmcnt(8)
    v_mfma_f32_32x32x16_bf16 v[48:63], v[128:131], v[80:83], 0
    v_exp_f32 v64, v64
    v_exp_f32 v65, v65
    v_exp_f32 v66, v66
    v_exp_f32 v67, v67
    v_exp_f32 v68, v68
    v_exp_f32 v69, v69
    v_mfma_f32_32x32x16_bf16 v[16:31], v[124:127], v[12:15], v[16:31]
    v_exp_f32 v70, v70
    v_exp_f32 v71, v71
    v_cvt_pk_bf16_f32 v8, v64, v65
    v_cvt_pk_bf16_f32 v9, v66, v67
    v_cvt_pk_bf16_f32 v10, v68, v69
    v_cvt_pk_bf16_f32 v11, v70, v71
    v_mfma_f32_32x32x16_bf16 v[48:63], v[132:135], v[84:87], v[48:63]
    v_exp_f32 v72, v72
    v_exp_f32 v73, v73
    v_exp_f32 v74, v74
    v_exp_f32 v75, v75
    v_exp_f32 v76, v76
    v_exp_f32 v77, v77
    v_mfma_f32_32x32x16_bf16 v[32:47], v[120:123], v[8:11], v[32:47]
    v_exp_f32 v78, v78
    v_exp_f32 v79, v79
    v_cvt_pk_bf16_f32 v12, v72, v73
    v_cvt_pk_bf16_f32 v13, v74, v75
    v_cvt_pk_bf16_f32 v14, v76, v77
    v_cvt_pk_bf16_f32 v15, v78, v79
    v_mfma_f32_32x32x16_bf16 v[64:79], v[128:131], v[88:91], 0
    v_exp_f32 v48, v48
    v_exp_f32 v49, v49
    v_exp_f32 v50, v50
    v_exp_f32 v51, v51
    v_exp_f32 v52, v52
    v_exp_f32 v53, v53
    v_mfma_f32_32x32x16_bf16 v[32:47], v[124:127], v[12:15], v[32:47]
    v_exp_f32 v54, v54
    v_exp_f32 v55, v55
    buffer_load_dwordx4 v[112:115], v2, s[32:35], s44 offen
    buffer_load_dwordx2 v[116:117], v3, s[32:35], s44 offen
    s_mov_b64 exec, s[46:47]
    buffer_load_dwordx4 v[120:123], v4, s[32:35], s45 offen
    buffer_load_dwordx4 v[124:127], v5, s[32:35], s45 offen
    s_mov_b64 exec, -1
    s_add_u32 s44, s44, 512
    s_add_u32 s45, s45, 40960
    v_cvt_pk_bf16_f32 v8, v48, v49
    v_cvt_pk_bf16_f32 v9, v50, v51
    v_cvt_pk_bf16_f32 v10, v52, v53
    v_cvt_pk_bf16_f32 v11, v54, v55
    v_mfma_f32_32x32x16_bf16 v[64:79], v[132:135], v[92:95], v[64:79]
    v_exp_f32 v56, v56
    v_exp_f32 v57, v57
    v_exp_f32 v58, v58
    v_exp_f32 v59, v59
    v_exp_f32 v60, v60
    v_exp_f32 v61, v61
    v_mfma_f32_32x32x16_bf16 v[16:31], v[136:139], v[8:11], v[16:31]
    v_exp_f32 v62, v62
    v_exp_f32 v63, v63
    v_cvt_pk_bf16_f32 v12, v56, v57
    v_cvt_pk_bf16_f32 v13, v58, v59
    v_cvt_pk_bf16_f32 v14, v60, v61
    v_cvt_pk_bf16_f32 v15, v62, v63
    s_waitcnt vmcnt(8)
    v_mfma_f32_32x32x16_bf16 v[48:63], v[144:147], v[80:83], 0
    v_exp_f32 v64, v64
    v_exp_f32 v65, v65
    v_exp_f32 v66, v66
    v_exp_f32 v67, v67
    v_exp_f32 v68, v68
    v_exp_f32 v69, v69
    v_mfma_f32_32x32x16_bf16 v[16:31], v[140:143], v[12:15], v[16:31]
    v_exp_f32 v70, v70
    v_exp_f32 v71, v71
    v_cvt_pk_bf16_f32 v8, v64, v65
    v_cvt_pk_bf16_f32 v9, v66, v67
    v_cvt_pk_bf16_f32 v10, v68, v69
    v_cvt_pk_bf16_f32 v11, v70, v71
    v_mfma_f32_32x32x16_bf16 v[48:63], v[148:151], v[84:87], v[48:63]
    v_exp_f32 v72, v72
    v_exp_f32 v73, v73
    v_exp_f32 v74, v74
    v_exp_f32 v75, v75
    v_exp_f32 v76, v76
    v_exp_f32 v77, v77
    v_mfma_f32_32x32x16_bf16 v[32:47], v[136:139], v[8:11], v[32:47]
    v_exp_f32 v78, v78
    v_exp_f32 v79, v79
    v_cvt_pk_bf16_f32 v12, v72, v73
    v_cvt_pk_bf16_f32 v13, v74, v75
    v_cvt_pk_bf16_f32 v14, v76, v77
    v_cvt_pk_bf16_f32 v15, v78, v79
    v_mfma_f32_32x32x16_bf16 v[64:79], v[144:147], v[88:91], 0
    v_exp_f32 v48, v48
    v_exp_f32 v49, v49
    v_exp_f32 v50, v50
    v_exp_f32 v51, v51
    v_exp_f32 v52, v52
    v_exp_f32 v53, v53
    v_mfma_f32_32x32x16_bf16 v[32:47], v[140:143], v[12:15], v[32:47]
    v_exp_f32 v54, v54
    v_exp_f32 v55, v55
    buffer_load_dwordx4 v[128:131], v2, s[32:35], s44 offen
    buffer_load_dwordx2 v[132:133], v3, s[32:35], s44 offen
    s_mov_b64 exec, s[46:47]
    buffer_load_dwordx4 v[136:139], v4, s[32:35], s45 offen
    buffer_load_dwordx4 v[140:143], v5, s[32:35], s45 offen
    s_mov_b64 exec, -1
    s_add_u32 s44, s44, 512
    s_add_u32 s45, s45, 40960
    v_cvt_pk_bf16_f32 v8, v48, v49
    v_cvt_pk_bf16_f32 v9, v50, v51
    v_cvt_pk_bf16_f32 v10, v52, v53
    v_cvt_pk_bf16_f32 v11, v54, v55
    v_mfma_f32_32x32x16_bf16 v[64:79], v[148:151], v[92:95], v[64:79]
    v_exp_f32 v56, v56
    v_exp_f32 v57, v57
    v_exp_f32 v58, v58
    v_exp_f32 v59, v59
    v_exp_f32 v60, v60
    v_exp_f32 v61, v61
    v_mfma_f32_32x32x16_bf16 v[16:31], v[152:155], v[8:11], v[16:31]
    v_exp_f32 v62, v62
    v_exp_f32 v63, v63
    v_cvt_pk_bf16_f32 v12, v56, v57
    v_cvt_pk_bf16_f32 v13, v58, v59
    v_cvt_pk_bf16_f32 v14, v60, v61
    v_cvt_pk_bf16_f32 v15, v62, v63
    s_waitcnt vmcnt(8)
    v_mfma_f32_32x32x16_bf16 v[48:63], v[96:99], v[80:83], 0
    v_exp_f32 v64, v64
    v_exp_f32 v65, v65
    v_exp_f32 v66, v66
    v_exp_f32 v67, v67
    v_exp_f32 v68, v68
    v_exp_f32 v69, v69
    v_mfma_f32_32x32x16_bf16 v[16:31], v[156:159], v[12:15], v[16:31]
    v_exp_f32 v70, v70
    v_exp_f32 v71, v71
    v_cvt_pk_bf16_f32 v8, v64, v65
    v_cvt_pk_bf16_f32 v9, v66, v67
    v_cvt_pk_bf16_f32 v10, v68, v69
    v_cvt_pk_bf16_f32 v11, v70, v71
    v_mfma_f32_32x32x16_bf16 v[48:63], v[100:103], v[84:87], v[48:63]
    v_exp_f32 v72, v72
    v_exp_f32 v73, v73
    v_exp_f32 v74, v74
    v_exp_f32 v75, v75
    v_exp_f32 v76, v76
    v_exp_f32 v77, v77
    v_mfma_f32_32x32x16_bf16 v[32:47], v[152:155], v[8:11], v[32:47]
    v_exp_f32 v78, v78
    v_exp_f32 v79, v79
    v_cvt_pk_bf16_f32 v12, v72, v73
    v_cvt_pk_bf16_f32 v13, v74, v75
    v_cvt_pk_bf16_f32 v14, v76, v77
    v_cvt_pk_bf16_f32 v15, v78, v79
    s_add_u32 s50, s50, 1
    s_cmp_lt_u32 s50, s43
    s_cbranch_scc1 L_ATT_LOOP
    s_nop 1
    v_mfma_f32_32x32x16_bf16 v[32:47], v[156:159], v[12:15], v[32:47]
    s_nop 7
    s_nop 7
    s_mov_b64 s[52:53], 0
    v_mov_b32 v161, 0x207
    v_mul_f32 v164, 0, v16
    v_mul_f32 v165, 0, v17
    v_fma_f32 v164, 0, v18, v164
    v_fma_f32 v165, 0, v19, v165
    v_fma_f32 v164, 0, v20, v164
    v_fma_f32 v165, 0, v21, v165
    v_fma_f32 v164, 0, v22, v164
    v_fma_f32 v165, 0, v23, v165
    v_fma_f32 v164, 0, v24, v164
    v_fma_f32 v165, 0, v25, v165
    v_fma_f32 v164, 0, v26, v164
    v_fma_f32 v165, 0, v27, v165
    v_add_f32 v164, v164, v165
    s_nop 0
    v_cmp_class_f32 vcc, v164, v161
    s_or_b64 s[52:53], s[52:53], vcc
    v_mov_b32 v160, v24
    v_mov_b32 v162, v24
    s_nop 1
    v_permlane32_swap_b32 v160, v162
    s_nop 1
    v_cmp_lt_f32 vcc, 0x71800000, v162
    s_or_b64 s[52:53], s[52:53], vcc
    v_mul_f32 v166, 0, v32
    v_mul_f32 v167, 0, v33
    v_fma_f32 v166, 0, v34, v166
    v_fma_f32 v167, 0, v35, v167
    v_fma_f32 v166, 0, v36, v166
    v_fma_f32 v167, 0, v37, v167
    v_fma_f32 v166, 0, v38, v166
    v_fma_f32 v167, 0, v39, v167
    v_fma_f32 v166, 0, v40, v166
    v_fma_f32 v167, 0, v41, v167
    v_fma_f32 v166, 0, v42, v166
    v_fma_f32 v167, 0, v43, v167
    v_add_f32 v166, v166, v167
    s_nop 0
    v_cmp_class_f32 vcc, v166, v161
    s_or_b64 s[52:53], s[52:53], vcc
    v_mov_b32 v160, v40
    v_mov_b32 v163, v40
    s_nop 1
    v_permlane32_swap_b32 v160, v163
    s_nop 1
    v_cmp_lt_f32 vcc, 0x71800000, v163
    s_or_b64 s[52:53], s[52:53], vcc
    s_cmp_eq_u64 s[52:53], 0
    s_cbranch_scc1 L_ATT_OK
    s_cmp_eq_u32 s48, 0
    s_cbranch_scc0 L_ATT_OK
    s_waitcnt vmcnt(0)
    s_mov_b32 s48, 1
    s_lshl_b32 s44, s42, 9
    s_lshl_b32 s50, s43, 2
    v_mov_b32 v86, 0
    v_mov_b32 v87, 0
    v_mov_b32 v6, 0xff800000
    v_mov_b32 v94, 0
    v_mov_b32 v95, 0
    v_mov_b32 v7, 0xff800000
L_ATT_MAXL:
    buffer_load_dwordx4 v[96:99], v2, s[32:35], s44 offen
    buffer_load_dwordx2 v[100:101], v3, s[32:35], s44 offen
    s_waitcnt vmcnt(0)
    v_mfma_f32_32x32x16_bf16 v[48:63], v[96:99], v[80:83], 0
    v_mfma_f32_32x32x16_bf16 v[48:63], v[100:103], v[84:87], v[48:63]
    v_mfma_f32_32x32x16_bf16 v[64:79], v[96:99], v[88:91], 0
    v_mfma_f32_32x32x16_bf16 v[64:79], v[100:103], v[92:95], v[64:79]
    s_nop 7
    s_nop 7
    v_max3_f32 v6, v6, v48, v49
    v_max3_f32 v6, v6, v50, v51
    v_max3_f32 v6, v6, v52, v53
    v_max3_f32 v6, v6, v54, v55
    v_max3_f32 v6, v6, v56, v57
    v_max3_f32 v6, v6, v58, v59
    v_max3_f32 v6, v6, v60, v61
    v_max3_f32 v6, v6, v62, v63
    v_max3_f32 v7, v7, v64, v65
    v_max3_f32 v7, v7, v66, v67
    v_max3_f32 v7, v7, v68, v69
    v_max3_f32 v7, v7, v70, v71
    v_max3_f32 v7, v7, v72, v73
    v_max3_f32 v7, v7, v74, v75
    v_max3_f32 v7, v7, v76, v77
    v_max3_f32 v7, v7, v78, v79
    s_add_u32 s44, s44, 512
    s_sub_u32 s50, s50, 1
    s_cmp_eq_u32 s50, 0
    s_cbranch_scc0 L_ATT_MAXL
    v_mov_b32 v160, v6
    s_nop 1
    v_permlane32_swap_b32 v6, v160
    s_nop 1
    v_max_f32 v6, v6, v160
    v_mov_b32 v160, v7
    s_nop 1
    v_permlane32_swap_b32 v7, v160
    s_nop 1
    v_max_f32 v7, v7, v160
    s_branch L_ATT_START
L_ATT_OK:
    v_rcp_f32 v160, v162
    v_log_f32 v161, v162
    s_nop 0
    v_mul_f32 v16, v160, v16
    v_mul_f32 v17, v160, v17
    v_mul_f32 v18, v160, v18
    v_mul_f32 v19, v160, v19
    v_mul_f32 v20, v160, v20
    v_mul_f32 v21, v160, v21
    v_mul_f32 v22, v160, v22
    v_mul_f32 v23, v160, v23
    v_mul_f32 v24, v160, v24
    v_mul_f32 v25, v160, v25
    v_mul_f32 v26, v160, v26
    v_mul_f32 v27, v160, v27
    v_add_f32 v6, v161, v6
    v_rcp_f32 v160, v163
    v_log_f32 v161, v163
    s_nop 0
    v_mul_f32 v32, v160, v32
    v_mul_f32 v33, v160, v33
    v_mul_f32 v34, v160, v34
    v_mul_f32 v35, v160, v35
    v_mul_f32 v36, v160, v36
    v_mul_f32 v37, v160, v37
    v_mul_f32 v38, v160, v38
    v_mul_f32 v39, v160, v39
    v_mul_f32 v40, v160, v40
    v_mul_f32 v41, v160, v41
    v_mul_f32 v42, v160, v42
    v_mul_f32 v43, v160, v43
    v_add_f32 v7, v161, v7
    s_lshl_b32 s52, s49, 2
    s_add_u32 s52, s52, s28
    s_mul_i32 s53, s52, 3328
    s_add_u32 s53, s53, 65536
    s_xor_b32 s52, s52, 4
    s_mul_i32 s54, s52, 3328
    s_add_u32 s54, s54, 65536
    v_lshlrev_b32 v10, 4, v0
    v_lshlrev_b32 v11, 2, v0
    v_add_u32 v12, s53, v10
    v_add_u32 v13, s53, v11
    ds_write_b128 v12, v[32:35] offset:0
    ds_write_b128 v12, v[36:39] offset:1024
    ds_write_b128 v12, v[40:43] offset:2048
    ds_write_b32 v13, v7 offset:3072
    s_waitcnt lgkmcnt(0)
    s_lshl_b32 s52, s28, 2
    s_add_u32 s52, s52, 92160
    v_mov_b32 v8, s52
    v_mov_b32 v9, 1
    s_mov_b64 exec, 1
    ds_add_u32 v8, v9
    s_mov_b64 exec, -1
    s_mov_b32 s71, 0
L_ATT_WM:
    ds_read_b32 v9, v8
    s_waitcnt lgkmcnt(0)
    v_cmp_gt_u32 vcc, 2, v9
    s_cbranch_vccz L_ATT_WM_ok
    s_add_u32 s71, s71, 1
    s_cmp_lt_u32 s71, 200000
    s_cbranch_scc0 L_ATT_WM_ok
    s_sleep 1
    s_branch L_ATT_WM
L_ATT_WM_ok:
    v_add_u32 v12, s54, v10
    v_add_u32 v13, s54, v11
    ds_read_b128 v[32:35], v12 offset:0
    ds_read_b128 v[36:39], v12 offset:1024
    ds_read_b128 v[40:43], v12 offset:2048
    ds_read_b32 v7, v13 offset:3072
    s_waitcnt lgkmcnt(0)
    v_max_f32 v160, v6, v7
    v_sub_f32 v161, v6, v160
    v_sub_f32 v162, v7, v160
    v_exp_f32 v161, v161
    v_exp_f32 v162, v162
    s_nop 0
    v_add_f32 v163, v161, v162
    v_rcp_f32 v163, v163
    s_nop 0
    v_mul_f32 v161, v161, v163
    v_mul_f32 v162, v162, v163
    v_mul_f32 v16, v161, v16
    v_fma_f32 v16, v162, v32, v16
    v_mul_f32 v17, v161, v17
    v_fma_f32 v17, v162, v33, v17
    v_mul_f32 v18, v161, v18
    v_fma_f32 v18, v162, v34, v18
    v_mul_f32 v19, v161, v19
    v_fma_f32 v19, v162, v35, v19
    v_mul_f32 v20, v161, v20
    v_fma_f32 v20, v162, v36, v20
    v_mul_f32 v21, v161, v21
    v_fma_f32 v21, v162, v37, v21
    v_mul_f32 v22, v161, v22
    v_fma_f32 v22, v162, v38, v22
    v_mul_f32 v23, v161, v23
    v_fma_f32 v23, v162, v39, v23
    v_mul_f32 v24, v161, v24
    v_fma_f32 v24, v162, v40, v24
    v_mul_f32 v25, v161, v25
    v_fma_f32 v25, v162, v41, v25
    v_mul_f32 v26, v161, v26
    v_fma_f32 v26, v162, v42, v26
    v_mul_f32 v27, v161, v27
    v_fma_f32 v27, v162, v43, v27
    v_cvt_pk_bf16_f32 v48, v16, v17
    v_cvt_pk_bf16_f32 v49, v18, v19
    v_cvt_pk_bf16_f32 v50, v20, v21
    v_cvt_pk_bf16_f32 v51, v22, v23
    v_cvt_pk_bf16_f32 v52, v24, v25
    v_cvt_pk_bf16_f32 v53, v26, v27
    s_lshr_b32 s52, s51, 4
    s_mul_i32 s52, s52, 20480
    s_lshr_b32 s53, s40, 1
    s_mul_i32 s53, s53, 5
    s_and_b32 s54, s40, 1
    s_mul_i32 s55, s54, 3
    s_add_u32 s55, s55, s53
    s_lshl_b32 s55, s55, 8
    s_add_u32 s55, s55, s52
    s_add_u32 s55, s55, 14286848
    s_add_u32 s53, s53, 2
    s_lshl_b32 s53, s53, 8
    s_lshl_b32 s54, s54, 3
    s_add_u32 s53, s53, s54
    s_add_u32 s53, s53, s52
    s_add_u32 s53, s53, 14286848
    v_bfe_u32 v10, v0, 4, 1
    v_mul_u32_u24 v10, 20480, v10
    v_and_b32 v11, 15, v0
    v_lshl_add_u32 v10, v11, 4, v10
    v_lshrrev_b32 v11, 5, v0
    v_lshl_add_u32 v11, v11, 8, v10
    buffer_store_dwordx4 v[48:51], v11, s[32:35], s55 offen sc1
    s_mov_b32 exec_hi, 0
    buffer_store_dwordx2 v[52:53], v10, s[32:35], s53 offen sc1
    s_mov_b64 exec, -1
    v_mov_b32 v8, 92208
    v_mov_b32 v9, 1
    s_mov_b64 exec, 1
    ds_add_u32 v8, v9
    s_mov_b64 exec, -1
    s_endpgm
L_K2_P:
    s_barrier
    s_and_b32 s52, s2, 7
    s_bfe_u32 s53, s2, 0x20003
    s_lshl_b32 s53, s53, 3
    s_add_u32 s40, s52, s53
    s_lshr_b32 s41, s2, 5
    s_mul_i32 s42, s41, 348160
    s_add_u32 s42, s42, 16908288
    s_mul_i32 s52, s28, 61440
    s_add_u32 s44, s42, s52
    s_add_u32 s45, s44, 4096
    s_mul_i32 s46, s40, 196608
    s_mul_i32 s52, s28, 12288
    s_add_u32 s46, s46, s52
    s_add_u32 s46, s46, 7995392
    v_lshlrev_b32 v2, 4, v0
    v_add_u32 v3, 49152, v2
    v_add_u32 v4, 98304, v2
    v_add_u32 v5, 147456, v2
    buffer_load_dwordx4 v[108:111], v2, s[32:35], s46 offen
    buffer_load_dwordx4 v[112:115], v3, s[32:35], s46 offen
    buffer_load_dwordx4 v[116:119], v4, s[32:35], s46 offen
    buffer_load_dwordx4 v[120:123], v5, s[32:35], s46 offen
    buffer_load_dwordx4 v[88:91], v2, s[32:35], s44 offen offset:0
    buffer_load_dwordx4 v[92:95], v2, s[32:35], s44 offen offset:1024
    buffer_load_dwordx4 v[96:99], v2, s[32:35], s44 offen offset:2048
    buffer_load_dwordx4 v[100:103], v2, s[32:35], s44 offen offset:3072
    buffer_load_dwordx4 v[104:107], v2, s[32:35], s45 offen
    s_add_u32 s44, s44, 5120
    s_add_u32 s45, s45, 5120
    s_add_u32 s46, s46, 1024
    buffer_load_dwordx4 v[144:147], v2, s[32:35], s46 offen
    buffer_load_dwordx4 v[148:151], v3, s[32:35], s46 offen
    buffer_load_dwordx4 v[152:155], v4, s[32:35], s46 offen
    buffer_load_dwordx4 v[156:159], v5, s[32:35], s46 offen
    buffer_load_dwordx4 v[124:127], v2, s[32:35], s44 offen offset:0
    buffer_load_dwordx4 v[128:131], v2, s[32:35], s44 offen offset:1024
    buffer_load_dwordx4 v[132:135], v2, s[32:35], s44 offen offset:2048
    buffer_load_dwordx4 v[136:139], v2, s[32:35], s44 offen offset:3072
    buffer_load_dwordx4 v[140:143], v2, s[32:35], s45 offen
    s_add_u32 s44, s44, 5120
    s_add_u32 s45, s45, 5120
    s_add_u32 s46, s46, 1024
    v_mov_b32 v8, 0
    v_mov_b32 v9, 0
    v_mov_b32 v10, 0
    v_mov_b32 v11, 0
    v_mov_b32 v12, 0
    v_mov_b32 v13, 0
    v_mov_b32 v14, 0
    v_mov_b32 v15, 0
    v_mov_b32 v16, 0
    v_mov_b32 v17, 0
    v_mov_b32 v18, 0
    v_mov_b32 v19, 0
    v_mov_b32 v20, 0
    v_mov_b32 v21, 0
    v_mov_b32 v22, 0
    v_mov_b32 v23, 0
    v_mov_b32 v24, 0
    v_mov_b32 v25, 0
    v_mov_b32 v26, 0
    v_mov_b32 v27, 0
    v_mov_b32 v28, 0
    v_mov_b32 v29, 0
    v_mov_b32 v30, 0
    v_mov_b32 v31, 0
    v_mov_b32 v32, 0
    v_mov_b32 v33, 0
    v_mov_b32 v34, 0
    v_mov_b32 v35, 0
    v_mov_b32 v36, 0
    v_mov_b32 v37, 0
    v_mov_b32 v38, 0
    v_mov_b32 v39, 0
    v_mov_b32 v40, 0
    v_mov_b32 v41, 0
    v_mov_b32 v42, 0
    v_mov_b32 v43, 0
    v_mov_b32 v44, 0
    v_mov_b32 v45, 0
    v_mov_b32 v46, 0
    v_mov_b32 v47, 0
    v_mov_b32 v48, 0
    v_mov_b32 v49, 0
    v_mov_b32 v50, 0
    v_mov_b32 v51, 0
    v_mov_b32 v52, 0
    v_mov_b32 v53, 0
    v_mov_b32 v54, 0
    v_mov_b32 v55, 0
    v_mov_b32 v56, 0
    v_mov_b32 v57, 0
    v_mov_b32 v58, 0
    v_mov_b32 v59, 0
    v_mov_b32 v60, 0
    v_mov_b32 v61, 0
    v_mov_b32 v62, 0
    v_mov_b32 v63, 0
    v_mov_b32 v64, 0
    v_mov_b32 v65, 0
    v_mov_b32 v66, 0
    v_mov_b32 v67, 0
    v_mov_b32 v68, 0
    v_mov_b32 v69, 0
    v_mov_b32 v70, 0
    v_mov_b32 v71, 0
    v_mov_b32 v72, 0
    v_mov_b32 v73, 0
    v_mov_b32 v74, 0
    v_mov_b32 v75, 0
    v_mov_b32 v76, 0
    v_mov_b32 v77, 0
    v_mov_b32 v78, 0
    v_mov_b32 v79, 0
    v_mov_b32 v80, 0
    v_mov_b32 v81, 0
    v_mov_b32 v82, 0
    v_mov_b32 v83, 0
    v_mov_b32 v84, 0
    v_mov_b32 v85, 0
    v_mov_b32 v86, 0
    v_mov_b32 v87, 0
    s_waitcnt vmcnt(13)
    v_mfma_f32_16x16x32_bf16 v[8:11], v[88:91], v[108:111], v[8:11]
    v_mfma_f32_16x16x32_bf16 v[28:31], v[88:91], v[112:115], v[28:31]
    v_mfma_f32_16x16x32_bf16 v[48:51], v[88:91], v[116:119], v[48:51]
    v_mfma_f32_16x16x32_bf16 v[68:71], v[88:91], v[120:123], v[68:71]
    s_waitcnt vmcnt(12)
    v_mfma_f32_16x16x32_bf16 v[12:15], v[92:95], v[108:111], v[12:15]
    v_mfma_f32_16x16x32_bf16 v[32:35], v[92:95], v[112:115], v[32:35]
    v_mfma_f32_16x16x32_bf16 v[52:55], v[92:95], v[116:119], v[52:55]
    v_mfma_f32_16x16x32_bf16 v[72:75], v[92:95], v[120:123], v[72:75]
    buffer_load_dwordx4 v[88:91], v2, s[32:35], s44 offen offset:0
    s_waitcnt vmcnt(12)
    v_mfma_f32_16x16x32_bf16 v[16:19], v[96:99], v[108:111], v[16:19]
    v_mfma_f32_16x16x32_bf16 v[36:39], v[96:99], v[112:115], v[36:39]
    v_mfma_f32_16x16x32_bf16 v[56:59], v[96:99], v[116:119], v[56:59]
    v_mfma_f32_16x16x32_bf16 v[76:79], v[96:99], v[120:123], v[76:79]
    buffer_load_dwordx4 v[92:95], v2, s[32:35], s44 offen offset:1024
    s_waitcnt vmcnt(12)
    v_mfma_f32_16x16x32_bf16 v[20:23], v[100:103], v[108:111], v[20:23]
    v_mfma_f32_16x16x32_bf16 v[40:43], v[100:103], v[112:115], v[40:43]
    v_mfma_f32_16x16x32_bf16 v[60:63], v[100:103], v[116:119], v[60:63]
    v_mfma_f32_16x16x32_bf16 v[80:83], v[100:103], v[120:123], v[80:83]
    buffer_load_dwordx4 v[96:99], v2, s[32:35], s44 offen offset:2048
    s_waitcnt vmcnt(12)
    v_mfma_f32_16x16x32_bf16 v[24:27], v[104:107], v[108:111], v[24:27]
    v_mfma_f32_16x16x32_bf16 v[44:47], v[104:107], v[112:115], v[44:47]
    v_mfma_f32_16x16x32_bf16 v[64:67], v[104:107], v[116:119], v[64:67]
    v_mfma_f32_16x16x32_bf16 v[84:87], v[104:107], v[120:123], v[84:87]
    buffer_load_dwordx4 v[100:103], v2, s[32:35], s44 offen offset:3072
    buffer_load_dwordx4 v[104:107], v2, s[32:35], s45 offen
    buffer_load_dwordx4 v[108:111], v2, s[32:35], s46 offen
    buffer_load_dwordx4 v[112:115], v3, s[32:35], s46 offen
    buffer_load_dwordx4 v[116:119], v4, s[32:35], s46 offen
    buffer_load_dwordx4 v[120:123], v5, s[32:35], s46 offen
    s_add_u32 s44, s44, 5120
    s_add_u32 s45, s45, 5120
    s_add_u32 s46, s46, 1024
    s_waitcnt vmcnt(13)
    v_mfma_f32_16x16x32_bf16 v[8:11], v[124:127], v[144:147], v[8:11]
    v_mfma_f32_16x16x32_bf16 v[28:31], v[124:127], v[148:151], v[28:31]
    v_mfma_f32_16x16x32_bf16 v[48:51], v[124:127], v[152:155], v[48:51]
    v_mfma_f32_16x16x32_bf16 v[68:71], v[124:127], v[156:159], v[68:71]
    s_waitcnt vmcnt(12)
    v_mfma_f32_16x16x32_bf16 v[12:15], v[128:131], v[144:147], v[12:15]
    v_mfma_f32_16x16x32_bf16 v[32:35], v[128:131], v[148:151], v[32:35]
    v_mfma_f32_16x16x32_bf16 v[52:55], v[128:131], v[152:155], v[52:55]
    v_mfma_f32_16x16x32_bf16 v[72:75], v[128:131], v[156:159], v[72:75]
    buffer_load_dwordx4 v[124:127], v2, s[32:35], s44 offen offset:0
    s_waitcnt vmcnt(12)
    v_mfma_f32_16x16x32_bf16 v[16:19], v[132:135], v[144:147], v[16:19]
    v_mfma_f32_16x16x32_bf16 v[36:39], v[132:135], v[148:151], v[36:39]
    v_mfma_f32_16x16x32_bf16 v[56:59], v[132:135], v[152:155], v[56:59]
    v_mfma_f32_16x16x32_bf16 v[76:79], v[132:135], v[156:159], v[76:79]
    buffer_load_dwordx4 v[128:131], v2, s[32:35], s44 offen offset:1024
    s_waitcnt vmcnt(12)
    v_mfma_f32_16x16x32_bf16 v[20:23], v[136:139], v[144:147], v[20:23]
    v_mfma_f32_16x16x32_bf16 v[40:43], v[136:139], v[148:151], v[40:43]
    v_mfma_f32_16x16x32_bf16 v[60:63], v[136:139], v[152:155], v[60:63]
    v_mfma_f32_16x16x32_bf16 v[80:83], v[136:139], v[156:159], v[80:83]
    buffer_load_dwordx4 v[132:135], v2, s[32:35], s44 offen offset:2048
    s_waitcnt vmcnt(12)
    v_mfma_f32_16x16x32_bf16 v[24:27], v[140:143], v[144:147], v[24:27]
    v_mfma_f32_16x16x32_bf16 v[44:47], v[140:143], v[148:151], v[44:47]
    v_mfma_f32_16x16x32_bf16 v[64:67], v[140:143], v[152:155], v[64:67]
    v_mfma_f32_16x16x32_bf16 v[84:87], v[140:143], v[156:159], v[84:87]
    buffer_load_dwordx4 v[136:139], v2, s[32:35], s44 offen offset:3072
    buffer_load_dwordx4 v[140:143], v2, s[32:35], s45 offen
    buffer_load_dwordx4 v[144:147], v2, s[32:35], s46 offen
    buffer_load_dwordx4 v[148:151], v3, s[32:35], s46 offen
    buffer_load_dwordx4 v[152:155], v4, s[32:35], s46 offen
    buffer_load_dwordx4 v[156:159], v5, s[32:35], s46 offen
    s_add_u32 s44, s44, 5120
    s_add_u32 s45, s45, 5120
    s_add_u32 s46, s46, 1024
    s_waitcnt vmcnt(9)
    v_mfma_f32_16x16x32_bf16 v[8:11], v[88:91], v[108:111], v[8:11]
    v_mfma_f32_16x16x32_bf16 v[28:31], v[88:91], v[112:115], v[28:31]
    v_mfma_f32_16x16x32_bf16 v[48:51], v[88:91], v[116:119], v[48:51]
    v_mfma_f32_16x16x32_bf16 v[68:71], v[88:91], v[120:123], v[68:71]
    s_waitcnt vmcnt(9)
    v_mfma_f32_16x16x32_bf16 v[12:15], v[92:95], v[108:111], v[12:15]
    v_mfma_f32_16x16x32_bf16 v[32:35], v[92:95], v[112:115], v[32:35]
    v_mfma_f32_16x16x32_bf16 v[52:55], v[92:95], v[116:119], v[52:55]
    v_mfma_f32_16x16x32_bf16 v[72:75], v[92:95], v[120:123], v[72:75]
    buffer_load_dwordx4 v[88:91], v2, s[32:35], s44 offen offset:0
    s_waitcnt vmcnt(10)
    v_mfma_f32_16x16x32_bf16 v[16:19], v[96:99], v[108:111], v[16:19]
    v_mfma_f32_16x16x32_bf16 v[36:39], v[96:99], v[112:115], v[36:39]
    v_mfma_f32_16x16x32_bf16 v[56:59], v[96:99], v[116:119], v[56:59]
    v_mfma_f32_16x16x32_bf16 v[76:79], v[96:99], v[120:123], v[76:79]
    buffer_load_dwordx4 v[92:95], v2, s[32:35], s44 offen offset:1024
    s_waitcnt vmcnt(11)
    v_mfma_f32_16x16x32_bf16 v[20:23], v[100:103], v[108:111], v[20:23]
    v_mfma_f32_16x16x32_bf16 v[40:43], v[100:103], v[112:115], v[40:43]
    v_mfma_f32_16x16x32_bf16 v[60:63], v[100:103], v[116:119], v[60:63]
    v_mfma_f32_16x16x32_bf16 v[80:83], v[100:103], v[120:123], v[80:83]
    buffer_load_dwordx4 v[96:99], v2, s[32:35], s44 offen offset:2048
    s_waitcnt vmcnt(12)
    v_mfma_f32_16x16x32_bf16 v[24:27], v[104:107], v[108:111], v[24:27]
    v_mfma_f32_16x16x32_bf16 v[44:47], v[104:107], v[112:115], v[44:47]
    v_mfma_f32_16x16x32_bf16 v[64:67], v[104:107], v[116:119], v[64:67]
    v_mfma_f32_16x16x32_bf16 v[84:87], v[104:107], v[120:123], v[84:87]
    buffer_load_dwordx4 v[100:103], v2, s[32:35], s44 offen offset:3072
    buffer_load_dwordx4 v[104:107], v2, s[32:35], s45 offen
    buffer_load_dwordx4 v[108:111], v2, s[32:35], s46 offen
    buffer_load_dwordx4 v[112:115], v3, s[32:35], s46 offen
    buffer_load_dwordx4 v[116:119], v4, s[32:35], s46 offen
    buffer_load_dwordx4 v[120:123], v5, s[32:35], s46 offen
    s_add_u32 s44, s44, 5120
    s_add_u32 s45, s45, 5120
    s_add_u32 s46, s46, 1024
    s_waitcnt vmcnt(9)
    v_mfma_f32_16x16x32_bf16 v[8:11], v[124:127], v[144:147], v[8:11]
    v_mfma_f32_16x16x32_bf16 v[28:31], v[124:127], v[148:151], v[28:31]
    v_mfma_f32_16x16x32_bf16 v[48:51], v[124:127], v[152:155], v[48:51]
    v_mfma_f32_16x16x32_bf16 v[68:71], v[124:127], v[156:159], v[68:71]
    s_waitcnt vmcnt(9)
    v_mfma_f32_16x16x32_bf16 v[12:15], v[128:131], v[144:147], v[12:15]
    v_mfma_f32_16x16x32_bf16 v[32:35], v[128:131], v[148:151], v[32:35]
    v_mfma_f32_16x16x32_bf16 v[52:55], v[128:131], v[152:155], v[52:55]
    v_mfma_f32_16x16x32_bf16 v[72:75], v[128:131], v[156:159], v[72:75]
    buffer_load_dwordx4 v[124:127], v2, s[32:35], s44 offen offset:0
    s_waitcnt vmcnt(10)
    v_mfma_f32_16x16x32_bf16 v[16:19], v[132:135], v[144:147], v[16:19]
    v_mfma_f32_16x16x32_bf16 v[36:39], v[132:135], v[148:151], v[36:39]
    v_mfma_f32_16x16x32_bf16 v[56:59], v[132:135], v[152:155], v[56:59]
    v_mfma_f32_16x16x32_bf16 v[76:79], v[132:135], v[156:159], v[76:79]
    buffer_load_dwordx4 v[128:131], v2, s[32:35], s44 offen offset:1024
    s_waitcnt vmcnt(11)
    v_mfma_f32_16x16x32_bf16 v[20:23], v[136:139], v[144:147], v[20:23]
    v_mfma_f32_16x16x32_bf16 v[40:43], v[136:139], v[148:151], v[40:43]
    v_mfma_f32_16x16x32_bf16 v[60:63], v[136:139], v[152:155], v[60:63]
    v_mfma_f32_16x16x32_bf16 v[80:83], v[136:139], v[156:159], v[80:83]
    buffer_load_dwordx4 v[132:135], v2, s[32:35], s44 offen offset:2048
    s_waitcnt vmcnt(12)
    v_mfma_f32_16x16x32_bf16 v[24:27], v[140:143], v[144:147], v[24:27]
    v_mfma_f32_16x16x32_bf16 v[44:47], v[140:143], v[148:151], v[44:47]
    v_mfma_f32_16x16x32_bf16 v[64:67], v[140:143], v[152:155], v[64:67]
    v_mfma_f32_16x16x32_bf16 v[84:87], v[140:143], v[156:159], v[84:87]
    buffer_load_dwordx4 v[136:139], v2, s[32:35], s44 offen offset:3072
    buffer_load_dwordx4 v[140:143], v2, s[32:35], s45 offen
    buffer_load_dwordx4 v[144:147], v2, s[32:35], s46 offen
    buffer_load_dwordx4 v[148:151], v3, s[32:35], s46 offen
    buffer_load_dwordx4 v[152:155], v4, s[32:35], s46 offen
    buffer_load_dwordx4 v[156:159], v5, s[32:35], s46 offen
    s_add_u32 s44, s44, 5120
    s_add_u32 s45, s45, 5120
    s_add_u32 s46, s46, 1024
    s_waitcnt vmcnt(9)
    v_mfma_f32_16x16x32_bf16 v[8:11], v[88:91], v[108:111], v[8:11]
    v_mfma_f32_16x16x32_bf16 v[28:31], v[88:91], v[112:115], v[28:31]
    v_mfma_f32_16x16x32_bf16 v[48:51], v[88:91], v[116:119], v[48:51]
    v_mfma_f32_16x16x32_bf16 v[68:71], v[88:91], v[120:123], v[68:71]
    s_waitcnt vmcnt(9)
    v_mfma_f32_16x16x32_bf16 v[12:15], v[92:95], v[108:111], v[12:15]
    v_mfma_f32_16x16x32_bf16 v[32:35], v[92:95], v[112:115], v[32:35]
    v_mfma_f32_16x16x32_bf16 v[52:55], v[92:95], v[116:119], v[52:55]
    v_mfma_f32_16x16x32_bf16 v[72:75], v[92:95], v[120:123], v[72:75]
    buffer_load_dwordx4 v[88:91], v2, s[32:35], s44 offen offset:0
    s_waitcnt vmcnt(10)
    v_mfma_f32_16x16x32_bf16 v[16:19], v[96:99], v[108:111], v[16:19]
    v_mfma_f32_16x16x32_bf16 v[36:39], v[96:99], v[112:115], v[36:39]
    v_mfma_f32_16x16x32_bf16 v[56:59], v[96:99], v[116:119], v[56:59]
    v_mfma_f32_16x16x32_bf16 v[76:79], v[96:99], v[120:123], v[76:79]
    buffer_load_dwordx4 v[92:95], v2, s[32:35], s44 offen offset:1024
    s_waitcnt vmcnt(11)
    v_mfma_f32_16x16x32_bf16 v[20:23], v[100:103], v[108:111], v[20:23]
    v_mfma_f32_16x16x32_bf16 v[40:43], v[100:103], v[112:115], v[40:43]
    v_mfma_f32_16x16x32_bf16 v[60:63], v[100:103], v[116:119], v[60:63]
    v_mfma_f32_16x16x32_bf16 v[80:83], v[100:103], v[120:123], v[80:83]
    buffer_load_dwordx4 v[96:99], v2, s[32:35], s44 offen offset:2048
    s_waitcnt vmcnt(12)
    v_mfma_f32_16x16x32_bf16 v[24:27], v[104:107], v[108:111], v[24:27]
    v_mfma_f32_16x16x32_bf16 v[44:47], v[104:107], v[112:115], v[44:47]
    v_mfma_f32_16x16x32_bf16 v[64:67], v[104:107], v[116:119], v[64:67]
    v_mfma_f32_16x16x32_bf16 v[84:87], v[104:107], v[120:123], v[84:87]
    buffer_load_dwordx4 v[100:103], v2, s[32:35], s44 offen offset:3072
    buffer_load_dwordx4 v[104:107], v2, s[32:35], s45 offen
    buffer_load_dwordx4 v[108:111], v2, s[32:35], s46 offen
    buffer_load_dwordx4 v[112:115], v3, s[32:35], s46 offen
    buffer_load_dwordx4 v[116:119], v4, s[32:35], s46 offen
    buffer_load_dwordx4 v[120:123], v5, s[32:35], s46 offen
    s_add_u32 s44, s44, 5120
    s_add_u32 s45, s45, 5120
    s_add_u32 s46, s46, 1024
    s_waitcnt vmcnt(9)
    v_mfma_f32_16x16x32_bf16 v[8:11], v[124:127], v[144:147], v[8:11]
    v_mfma_f32_16x16x32_bf16 v[28:31], v[124:127], v[148:151], v[28:31]
    v_mfma_f32_16x16x32_bf16 v[48:51], v[124:127], v[152:155], v[48:51]
    v_mfma_f32_16x16x32_bf16 v[68:71], v[124:127], v[156:159], v[68:71]
    s_waitcnt vmcnt(9)
    v_mfma_f32_16x16x32_bf16 v[12:15], v[128:131], v[144:147], v[12:15]
    v_mfma_f32_16x16x32_bf16 v[32:35], v[128:131], v[148:151], v[32:35]
    v_mfma_f32_16x16x32_bf16 v[52:55], v[128:131], v[152:155], v[52:55]
    v_mfma_f32_16x16x32_bf16 v[72:75], v[128:131], v[156:159], v[72:75]
    buffer_load_dwordx4 v[124:127], v2, s[32:35], s44 offen offset:0
    s_waitcnt vmcnt(10)
    v_mfma_f32_16x16x32_bf16 v[16:19], v[132:135], v[144:147], v[16:19]
    v_mfma_f32_16x16x32_bf16 v[36:39], v[132:135], v[148:151], v[36:39]
    v_mfma_f32_16x16x32_bf16 v[56:59], v[132:135], v[152:155], v[56:59]
    v_mfma_f32_16x16x32_bf16 v[76:79], v[132:135], v[156:159], v[76:79]
    buffer_load_dwordx4 v[128:131], v2, s[32:35], s44 offen offset:1024
    s_waitcnt vmcnt(11)
    v_mfma_f32_16x16x32_bf16 v[20:23], v[136:139], v[144:147], v[20:23]
    v_mfma_f32_16x16x32_bf16 v[40:43], v[136:139], v[148:151], v[40:43]
    v_mfma_f32_16x16x32_bf16 v[60:63], v[136:139], v[152:155], v[60:63]
    v_mfma_f32_16x16x32_bf16 v[80:83], v[136:139], v[156:159], v[80:83]
    buffer_load_dwordx4 v[132:135], v2, s[32:35], s44 offen offset:2048
    s_waitcnt vmcnt(12)
    v_mfma_f32_16x16x32_bf16 v[24:27], v[140:143], v[144:147], v[24:27]
    v_mfma_f32_16x16x32_bf16 v[44:47], v[140:143], v[148:151], v[44:47]
    v_mfma_f32_16x16x32_bf16 v[64:67], v[140:143], v[152:155], v[64:67]
    v_mfma_f32_16x16x32_bf16 v[84:87], v[140:143], v[156:159], v[84:87]
    buffer_load_dwordx4 v[136:139], v2, s[32:35], s44 offen offset:3072
    buffer_load_dwordx4 v[140:143], v2, s[32:35], s45 offen
    buffer_load_dwordx4 v[144:147], v2, s[32:35], s46 offen
    buffer_load_dwordx4 v[148:151], v3, s[32:35], s46 offen
    buffer_load_dwordx4 v[152:155], v4, s[32:35], s46 offen
    buffer_load_dwordx4 v[156:159], v5, s[32:35], s46 offen
    s_add_u32 s44, s44, 5120
    s_add_u32 s45, s45, 5120
    s_add_u32 s46, s46, 1024
    s_waitcnt vmcnt(9)
    v_mfma_f32_16x16x32_bf16 v[8:11], v[88:91], v[108:111], v[8:11]
    v_mfma_f32_16x16x32_bf16 v[28:31], v[88:91], v[112:115], v[28:31]
    v_mfma_f32_16x16x32_bf16 v[48:51], v[88:91], v[116:119], v[48:51]
    v_mfma_f32_16x16x32_bf16 v[68:71], v[88:91], v[120:123], v[68:71]
    s_waitcnt vmcnt(9)
    v_mfma_f32_16x16x32_bf16 v[12:15], v[92:95], v[108:111], v[12:15]
    v_mfma_f32_16x16x32_bf16 v[32:35], v[92:95], v[112:115], v[32:35]
    v_mfma_f32_16x16x32_bf16 v[52:55], v[92:95], v[116:119], v[52:55]
    v_mfma_f32_16x16x32_bf16 v[72:75], v[92:95], v[120:123], v[72:75]
    buffer_load_dwordx4 v[88:91], v2, s[32:35], s44 offen offset:0
    s_waitcnt vmcnt(10)
    v_mfma_f32_16x16x32_bf16 v[16:19], v[96:99], v[108:111], v[16:19]
    v_mfma_f32_16x16x32_bf16 v[36:39], v[96:99], v[112:115], v[36:39]
    v_mfma_f32_16x16x32_bf16 v[56:59], v[96:99], v[116:119], v[56:59]
    v_mfma_f32_16x16x32_bf16 v[76:79], v[96:99], v[120:123], v[76:79]
    buffer_load_dwordx4 v[92:95], v2, s[32:35], s44 offen offset:1024
    s_waitcnt vmcnt(11)
    v_mfma_f32_16x16x32_bf16 v[20:23], v[100:103], v[108:111], v[20:23]
    v_mfma_f32_16x16x32_bf16 v[40:43], v[100:103], v[112:115], v[40:43]
    v_mfma_f32_16x16x32_bf16 v[60:63], v[100:103], v[116:119], v[60:63]
    v_mfma_f32_16x16x32_bf16 v[80:83], v[100:103], v[120:123], v[80:83]
    buffer_load_dwordx4 v[96:99], v2, s[32:35], s44 offen offset:2048
    s_waitcnt vmcnt(12)
    v_mfma_f32_16x16x32_bf16 v[24:27], v[104:107], v[108:111], v[24:27]
    v_mfma_f32_16x16x32_bf16 v[44:47], v[104:107], v[112:115], v[44:47]
    v_mfma_f32_16x16x32_bf16 v[64:67], v[104:107], v[116:119], v[64:67]
    v_mfma_f32_16x16x32_bf16 v[84:87], v[104:107], v[120:123], v[84:87]
    buffer_load_dwordx4 v[100:103], v2, s[32:35], s44 offen offset:3072
    buffer_load_dwordx4 v[104:107], v2, s[32:35], s45 offen
    buffer_load_dwordx4 v[108:111], v2, s[32:35], s46 offen
    buffer_load_dwordx4 v[112:115], v3, s[32:35], s46 offen
    buffer_load_dwordx4 v[116:119], v4, s[32:35], s46 offen
    buffer_load_dwordx4 v[120:123], v5, s[32:35], s46 offen
    s_add_u32 s44, s44, 5120
    s_add_u32 s45, s45, 5120
    s_add_u32 s46, s46, 1024
    s_waitcnt vmcnt(9)
    v_mfma_f32_16x16x32_bf16 v[8:11], v[124:127], v[144:147], v[8:11]
    v_mfma_f32_16x16x32_bf16 v[28:31], v[124:127], v[148:151], v[28:31]
    v_mfma_f32_16x16x32_bf16 v[48:51], v[124:127], v[152:155], v[48:51]
    v_mfma_f32_16x16x32_bf16 v[68:71], v[124:127], v[156:159], v[68:71]
    s_waitcnt vmcnt(9)
    v_mfma_f32_16x16x32_bf16 v[12:15], v[128:131], v[144:147], v[12:15]
    v_mfma_f32_16x16x32_bf16 v[32:35], v[128:131], v[148:151], v[32:35]
    v_mfma_f32_16x16x32_bf16 v[52:55], v[128:131], v[152:155], v[52:55]
    v_mfma_f32_16x16x32_bf16 v[72:75], v[128:131], v[156:159], v[72:75]
    buffer_load_dwordx4 v[124:127], v2, s[32:35], s44 offen offset:0
    s_waitcnt vmcnt(10)
    v_mfma_f32_16x16x32_bf16 v[16:19], v[132:135], v[144:147], v[16:19]
    v_mfma_f32_16x16x32_bf16 v[36:39], v[132:135], v[148:151], v[36:39]
    v_mfma_f32_16x16x32_bf16 v[56:59], v[132:135], v[152:155], v[56:59]
    v_mfma_f32_16x16x32_bf16 v[76:79], v[132:135], v[156:159], v[76:79]
    buffer_load_dwordx4 v[128:131], v2, s[32:35], s44 offen offset:1024
    s_waitcnt vmcnt(11)
    v_mfma_f32_16x16x32_bf16 v[20:23], v[136:139], v[144:147], v[20:23]
    v_mfma_f32_16x16x32_bf16 v[40:43], v[136:139], v[148:151], v[40:43]
    v_mfma_f32_16x16x32_bf16 v[60:63], v[136:139], v[152:155], v[60:63]
    v_mfma_f32_16x16x32_bf16 v[80:83], v[136:139], v[156:159], v[80:83]
    buffer_load_dwordx4 v[132:135], v2, s[32:35], s44 offen offset:2048
    s_waitcnt vmcnt(12)
    v_mfma_f32_16x16x32_bf16 v[24:27], v[140:143], v[144:147], v[24:27]
    v_mfma_f32_16x16x32_bf16 v[44:47], v[140:143], v[148:151], v[44:47]
    v_mfma_f32_16x16x32_bf16 v[64:67], v[140:143], v[152:155], v[64:67]
    v_mfma_f32_16x16x32_bf16 v[84:87], v[140:143], v[156:159], v[84:87]
    buffer_load_dwordx4 v[136:139], v2, s[32:35], s44 offen offset:3072
    buffer_load_dwordx4 v[140:143], v2, s[32:35], s45 offen
    buffer_load_dwordx4 v[144:147], v2, s[32:35], s46 offen
    buffer_load_dwordx4 v[148:151], v3, s[32:35], s46 offen
    buffer_load_dwordx4 v[152:155], v4, s[32:35], s46 offen
    buffer_load_dwordx4 v[156:159], v5, s[32:35], s46 offen
    s_add_u32 s44, s44, 5120
    s_add_u32 s45, s45, 5120
    s_add_u32 s46, s46, 1024
    s_waitcnt vmcnt(9)
    v_mfma_f32_16x16x32_bf16 v[8:11], v[88:91], v[108:111], v[8:11]
    v_mfma_f32_16x16x32_bf16 v[28:31], v[88:91], v[112:115], v[28:31]
    v_mfma_f32_16x16x32_bf16 v[48:51], v[88:91], v[116:119], v[48:51]
    v_mfma_f32_16x16x32_bf16 v[68:71], v[88:91], v[120:123], v[68:71]
    s_waitcnt vmcnt(9)
    v_mfma_f32_16x16x32_bf16 v[12:15], v[92:95], v[108:111], v[12:15]
    v_mfma_f32_16x16x32_bf16 v[32:35], v[92:95], v[112:115], v[32:35]
    v_mfma_f32_16x16x32_bf16 v[52:55], v[92:95], v[116:119], v[52:55]
    v_mfma_f32_16x16x32_bf16 v[72:75], v[92:95], v[120:123], v[72:75]
    buffer_load_dwordx4 v[88:91], v2, s[32:35], s44 offen offset:0
    s_waitcnt vmcnt(10)
    v_mfma_f32_16x16x32_bf16 v[16:19], v[96:99], v[108:111], v[16:19]
    v_mfma_f32_16x16x32_bf16 v[36:39], v[96:99], v[112:115], v[36:39]
    v_mfma_f32_16x16x32_bf16 v[56:59], v[96:99], v[116:119], v[56:59]
    v_mfma_f32_16x16x32_bf16 v[76:79], v[96:99], v[120:123], v[76:79]
    buffer_load_dwordx4 v[92:95], v2, s[32:35], s44 offen offset:1024
    s_waitcnt vmcnt(11)
    v_mfma_f32_16x16x32_bf16 v[20:23], v[100:103], v[108:111], v[20:23]
    v_mfma_f32_16x16x32_bf16 v[40:43], v[100:103], v[112:115], v[40:43]
    v_mfma_f32_16x16x32_bf16 v[60:63], v[100:103], v[116:119], v[60:63]
    v_mfma_f32_16x16x32_bf16 v[80:83], v[100:103], v[120:123], v[80:83]
    buffer_load_dwordx4 v[96:99], v2, s[32:35], s44 offen offset:2048
    s_waitcnt vmcnt(12)
    v_mfma_f32_16x16x32_bf16 v[24:27], v[104:107], v[108:111], v[24:27]
    v_mfma_f32_16x16x32_bf16 v[44:47], v[104:107], v[112:115], v[44:47]
    v_mfma_f32_16x16x32_bf16 v[64:67], v[104:107], v[116:119], v[64:67]
    v_mfma_f32_16x16x32_bf16 v[84:87], v[104:107], v[120:123], v[84:87]
    buffer_load_dwordx4 v[100:103], v2, s[32:35], s44 offen offset:3072
    buffer_load_dwordx4 v[104:107], v2, s[32:35], s45 offen
    buffer_load_dwordx4 v[108:111], v2, s[32:35], s46 offen
    buffer_load_dwordx4 v[112:115], v3, s[32:35], s46 offen
    buffer_load_dwordx4 v[116:119], v4, s[32:35], s46 offen
    buffer_load_dwordx4 v[120:123], v5, s[32:35], s46 offen
    s_add_u32 s44, s44, 5120
    s_add_u32 s45, s45, 5120
    s_add_u32 s46, s46, 1024
    s_waitcnt vmcnt(9)
    v_mfma_f32_16x16x32_bf16 v[8:11], v[124:127], v[144:147], v[8:11]
    v_mfma_f32_16x16x32_bf16 v[28:31], v[124:127], v[148:151], v[28:31]
    v_mfma_f32_16x16x32_bf16 v[48:51], v[124:127], v[152:155], v[48:51]
    v_mfma_f32_16x16x32_bf16 v[68:71], v[124:127], v[156:159], v[68:71]
    s_waitcnt vmcnt(9)
    v_mfma_f32_16x16x32_bf16 v[12:15], v[128:131], v[144:147], v[12:15]
    v_mfma_f32_16x16x32_bf16 v[32:35], v[128:131], v[148:151], v[32:35]
    v_mfma_f32_16x16x32_bf16 v[52:55], v[128:131], v[152:155], v[52:55]
    v_mfma_f32_16x16x32_bf16 v[72:75], v[128:131], v[156:159], v[72:75]
    buffer_load_dwordx4 v[124:127], v2, s[32:35], s44 offen offset:0
    s_waitcnt vmcnt(10)
    v_mfma_f32_16x16x32_bf16 v[16:19], v[132:135], v[144:147], v[16:19]
    v_mfma_f32_16x16x32_bf16 v[36:39], v[132:135], v[148:151], v[36:39]
    v_mfma_f32_16x16x32_bf16 v[56:59], v[132:135], v[152:155], v[56:59]
    v_mfma_f32_16x16x32_bf16 v[76:79], v[132:135], v[156:159], v[76:79]
    buffer_load_dwordx4 v[128:131], v2, s[32:35], s44 offen offset:1024
    s_waitcnt vmcnt(11)
    v_mfma_f32_16x16x32_bf16 v[20:23], v[136:139], v[144:147], v[20:23]
    v_mfma_f32_16x16x32_bf16 v[40:43], v[136:139], v[148:151], v[40:43]
    v_mfma_f32_16x16x32_bf16 v[60:63], v[136:139], v[152:155], v[60:63]
    v_mfma_f32_16x16x32_bf16 v[80:83], v[136:139], v[156:159], v[80:83]
    buffer_load_dwordx4 v[132:135], v2, s[32:35], s44 offen offset:2048
    s_waitcnt vmcnt(12)
    v_mfma_f32_16x16x32_bf16 v[24:27], v[140:143], v[144:147], v[24:27]
    v_mfma_f32_16x16x32_bf16 v[44:47], v[140:143], v[148:151], v[44:47]
    v_mfma_f32_16x16x32_bf16 v[64:67], v[140:143], v[152:155], v[64:67]
    v_mfma_f32_16x16x32_bf16 v[84:87], v[140:143], v[156:159], v[84:87]
    buffer_load_dwordx4 v[136:139], v2, s[32:35], s44 offen offset:3072
    buffer_load_dwordx4 v[140:143], v2, s[32:35], s45 offen
    buffer_load_dwordx4 v[144:147], v2, s[32:35], s46 offen
    buffer_load_dwordx4 v[148:151], v3, s[32:35], s46 offen
    buffer_load_dwordx4 v[152:155], v4, s[32:35], s46 offen
    buffer_load_dwordx4 v[156:159], v5, s[32:35], s46 offen
    s_add_u32 s44, s44, 5120
    s_add_u32 s45, s45, 5120
    s_add_u32 s46, s46, 1024
    s_waitcnt vmcnt(9)
    v_mfma_f32_16x16x32_bf16 v[8:11], v[88:91], v[108:111], v[8:11]
    v_mfma_f32_16x16x32_bf16 v[28:31], v[88:91], v[112:115], v[28:31]
    v_mfma_f32_16x16x32_bf16 v[48:51], v[88:91], v[116:119], v[48:51]
    v_mfma_f32_16x16x32_bf16 v[68:71], v[88:91], v[120:123], v[68:71]
    s_waitcnt vmcnt(9)
    v_mfma_f32_16x16x32_bf16 v[12:15], v[92:95], v[108:111], v[12:15]
    v_mfma_f32_16x16x32_bf16 v[32:35], v[92:95], v[112:115], v[32:35]
    v_mfma_f32_16x16x32_bf16 v[52:55], v[92:95], v[116:119], v[52:55]
    v_mfma_f32_16x16x32_bf16 v[72:75], v[92:95], v[120:123], v[72:75]
    s_waitcnt vmcnt(9)
    v_mfma_f32_16x16x32_bf16 v[16:19], v[96:99], v[108:111], v[16:19]
    v_mfma_f32_16x16x32_bf16 v[36:39], v[96:99], v[112:115], v[36:39]
    v_mfma_f32_16x16x32_bf16 v[56:59], v[96:99], v[116:119], v[56:59]
    v_mfma_f32_16x16x32_bf16 v[76:79], v[96:99], v[120:123], v[76:79]
    s_waitcnt vmcnt(9)
    v_mfma_f32_16x16x32_bf16 v[20:23], v[100:103], v[108:111], v[20:23]
    v_mfma_f32_16x16x32_bf16 v[40:43], v[100:103], v[112:115], v[40:43]
    v_mfma_f32_16x16x32_bf16 v[60:63], v[100:103], v[116:119], v[60:63]
    v_mfma_f32_16x16x32_bf16 v[80:83], v[100:103], v[120:123], v[80:83]
    s_waitcnt vmcnt(9)
    v_mfma_f32_16x16x32_bf16 v[24:27], v[104:107], v[108:111], v[24:27]
    v_mfma_f32_16x16x32_bf16 v[44:47], v[104:107], v[112:115], v[44:47]
    v_mfma_f32_16x16x32_bf16 v[64:67], v[104:107], v[116:119], v[64:67]
    v_mfma_f32_16x16x32_bf16 v[84:87], v[104:107], v[120:123], v[84:87]
    s_waitcnt vmcnt(0)
    v_mfma_f32_16x16x32_bf16 v[8:11], v[124:127], v[144:147], v[8:11]
    v_mfma_f32_16x16x32_bf16 v[28:31], v[124:127], v[148:151], v[28:31]
    v_mfma_f32_16x16x32_bf16 v[48:51], v[124:127], v[152:155], v[48:51]
    v_mfma_f32_16x16x32_bf16 v[68:71], v[124:127], v[156:159], v[68:71]
    s_waitcnt vmcnt(0)
    v_mfma_f32_16x16x32_bf16 v[12:15], v[128:131], v[144:147], v[12:15]
    v_mfma_f32_16x16x32_bf16 v[32:35], v[128:131], v[148:151], v[32:35]
    v_mfma_f32_16x16x32_bf16 v[52:55], v[128:131], v[152:155], v[52:55]
    v_mfma_f32_16x16x32_bf16 v[72:75], v[128:131], v[156:159], v[72:75]
    s_waitcnt vmcnt(0)
    v_mfma_f32_16x16x32_bf16 v[16:19], v[132:135], v[144:147], v[16:19]
    v_mfma_f32_16x16x32_bf16 v[36:39], v[132:135], v[148:151], v[36:39]
    v_mfma_f32_16x16x32_bf16 v[56:59], v[132:135], v[152:155], v[56:59]
    v_mfma_f32_16x16x32_bf16 v[76:79], v[132:135], v[156:159], v[76:79]
    s_waitcnt vmcnt(0)
    v_mfma_f32_16x16x32_bf16 v[20:23], v[136:139], v[144:147], v[20:23]
    v_mfma_f32_16x16x32_bf16 v[40:43], v[136:139], v[148:151], v[40:43]
    v_mfma_f32_16x16x32_bf16 v[60:63], v[136:139], v[152:155], v[60:63]
    v_mfma_f32_16x16x32_bf16 v[80:83], v[136:139], v[156:159], v[80:83]
    s_waitcnt vmcnt(0)
    v_mfma_f32_16x16x32_bf16 v[24:27], v[140:143], v[144:147], v[24:27]
    v_mfma_f32_16x16x32_bf16 v[44:47], v[140:143], v[148:151], v[44:47]
    v_mfma_f32_16x16x32_bf16 v[64:67], v[140:143], v[152:155], v[64:67]
    v_mfma_f32_16x16x32_bf16 v[84:87], v[140:143], v[156:159], v[84:87]
    s_nop 7
    v_lshlrev_b32 v2, 4, v0
    s_mul_i32 s52, s28, 10240
    s_add_u32 s53, s52, s42
    s_add_u32 s53, s53, 307200
    s_add_u32 s52, s52, 92416
    s_mov_b32 m0, s52
    s_nop 0
    buffer_load_dwordx4 v2, s[32:35], s53 offen offset:0 lds
    buffer_load_dwordx4 v2, s[32:35], s53 offen offset:1024 lds
    buffer_load_dwordx4 v2, s[32:35], s53 offen offset:2048 lds
    buffer_load_dwordx4 v2, s[32:35], s53 offen offset:3072 lds
    s_add_u32 m0, s52, 4096
    s_add_u32 s54, s53, 4096
    buffer_load_dwordx4 v2, s[32:35], s54 offen lds
    s_add_u32 s52, s52, 5120
    s_add_u32 s53, s53, 5120
    s_mov_b32 m0, s52
    s_nop 0
    buffer_load_dwordx4 v2, s[32:35], s53 offen offset:0 lds
    buffer_load_dwordx4 v2, s[32:35], s53 offen offset:1024 lds
    buffer_load_dwordx4 v2, s[32:35], s53 offen offset:2048 lds
    buffer_load_dwordx4 v2, s[32:35], s53 offen offset:3072 lds
    s_add_u32 m0, s52, 4096
    s_add_u32 s54, s53, 4096
    buffer_load_dwordx4 v2, s[32:35], s54 offen lds
    s_add_u32 s52, s52, 5120
    s_add_u32 s53, s53, 5120
    s_cmp_eq_u32 s28, 0
    s_cbranch_scc1 L_P3_OWN0
    s_sub_u32 s52, s28, 0
    s_and_b32 s52, s52, 3
    s_sub_u32 s52, s52, 1
    s_mul_i32 s52, s52, 5120
    s_add_u32 s52, s52, 0
    v_add_u32 v3, s52, v2
    ds_write_b128 v3, v[8:11] offset:0
    ds_write_b128 v3, v[12:15] offset:1024
    ds_write_b128 v3, v[16:19] offset:2048
    ds_write_b128 v3, v[20:23] offset:3072
    ds_write_b128 v3, v[24:27] offset:4096
    s_branch L_P3_NXT0
L_P3_OWN0:
    v_mov_b32 v88, v8
    v_mov_b32 v89, v9
    v_mov_b32 v90, v10
    v_mov_b32 v91, v11
    v_mov_b32 v92, v12
    v_mov_b32 v93, v13
    v_mov_b32 v94, v14
    v_mov_b32 v95, v15
    v_mov_b32 v96, v16
    v_mov_b32 v97, v17
    v_mov_b32 v98, v18
    v_mov_b32 v99, v19
    v_mov_b32 v100, v20
    v_mov_b32 v101, v21
    v_mov_b32 v102, v22
    v_mov_b32 v103, v23
    v_mov_b32 v104, v24
    v_mov_b32 v105, v25
    v_mov_b32 v106, v26
    v_mov_b32 v107, v27
L_P3_NXT0:
    s_cmp_eq_u32 s28, 1
    s_cbranch_scc1 L_P3_OWN1
    s_sub_u32 s52, s28, 1
    s_and_b32 s52, s52, 3
    s_sub_u32 s52, s52, 1
    s_mul_i32 s52, s52, 5120
    s_add_u32 s52, s52, 15360
    v_add_u32 v3, s52, v2
    ds_write_b128 v3, v[28:31] offset:0
    ds_write_b128 v3, v[32:35] offset:1024
    ds_write_b128 v3, v[36:39] offset:2048
    ds_write_b128 v3, v[40:43] offset:3072
    ds_write_b128 v3, v[44:47] offset:4096
    s_branch L_P3_NXT1
L_P3_OWN1:
    v_mov_b32 v88, v28
    v_mov_b32 v89, v29
    v_mov_b32 v90, v30
    v_mov_b32 v91, v31
    v_mov_b32 v92, v32
    v_mov_b32 v93, v33
    v_mov_b32 v94, v34
    v_mov_b32 v95, v35
    v_mov_b32 v96, v36
    v_mov_b32 v97, v37
    v_mov_b32 v98, v38
    v_mov_b32 v99, v39
    v_mov_b32 v100, v40
    v_mov_b32 v101, v41
    v_mov_b32 v102, v42
    v_mov_b32 v103, v43
    v_mov_b32 v104, v44
    v_mov_b32 v105, v45
    v_mov_b32 v106, v46
    v_mov_b32 v107, v47
L_P3_NXT1:
    s_cmp_eq_u32 s28, 2
    s_cbranch_scc1 L_P3_OWN2
    s_sub_u32 s52, s28, 2
    s_and_b32 s52, s52, 3
    s_sub_u32 s52, s52, 1
    s_mul_i32 s52, s52, 5120
    s_add_u32 s52, s52, 30720
    v_add_u32 v3, s52, v2
    ds_write_b128 v3, v[48:51] offset:0
    ds_write_b128 v3, v[52:55] offset:1024
    ds_write_b128 v3, v[56:59] offset:2048
    ds_write_b128 v3, v[60:63] offset:3072
    ds_write_b128 v3, v[64:67] offset:4096
    s_branch L_P3_NXT2
L_P3_OWN2:
    v_mov_b32 v88, v48
    v_mov_b32 v89, v49
    v_mov_b32 v90, v50
    v_mov_b32 v91, v51
    v_mov_b32 v92, v52
    v_mov_b32 v93, v53
    v_mov_b32 v94, v54
    v_mov_b32 v95, v55
    v_mov_b32 v96, v56
    v_mov_b32 v97, v57
    v_mov_b32 v98, v58
    v_mov_b32 v99, v59
    v_mov_b32 v100, v60
    v_mov_b32 v101, v61
    v_mov_b32 v102, v62
    v_mov_b32 v103, v63
    v_mov_b32 v104, v64
    v_mov_b32 v105, v65
    v_mov_b32 v106, v66
    v_mov_b32 v107, v67
L_P3_NXT2:
    s_cmp_eq_u32 s28, 3
    s_cbranch_scc1 L_P3_OWN3
    s_sub_u32 s52, s28, 3
    s_and_b32 s52, s52, 3
    s_sub_u32 s52, s52, 1
    s_mul_i32 s52, s52, 5120
    s_add_u32 s52, s52, 46080
    v_add_u32 v3, s52, v2
    ds_write_b128 v3, v[68:71] offset:0
    ds_write_b128 v3, v[72:75] offset:1024
    ds_write_b128 v3, v[76:79] offset:2048
    ds_write_b128 v3, v[80:83] offset:3072
    ds_write_b128 v3, v[84:87] offset:4096
    s_branch L_P3_NXT3
L_P3_OWN3:
    v_mov_b32 v88, v68
    v_mov_b32 v89, v69
    v_mov_b32 v90, v70
    v_mov_b32 v91, v71
    v_mov_b32 v92, v72
    v_mov_b32 v93, v73
    v_mov_b32 v94, v74
    v_mov_b32 v95, v75
    v_mov_b32 v96, v76
    v_mov_b32 v97, v77
    v_mov_b32 v98, v78
    v_mov_b32 v99, v79
    v_mov_b32 v100, v80
    v_mov_b32 v101, v81
    v_mov_b32 v102, v82
    v_mov_b32 v103, v83
    v_mov_b32 v104, v84
    v_mov_b32 v105, v85
    v_mov_b32 v106, v86
    v_mov_b32 v107, v87
L_P3_NXT3:
    s_waitcnt lgkmcnt(0)
    v_mov_b32 v6, 92192
    v_mov_b32 v7, 1
    s_mov_b64 exec, 1
    ds_add_u32 v6, v7
    s_mov_b64 exec, -1
    s_mov_b32 s71, 0
L_P3_R1:
    ds_read_b32 v7, v6
    s_waitcnt lgkmcnt(0)
    v_cmp_gt_u32 vcc, 4, v7
    s_cbranch_vccz L_P3_R1_ok
    s_add_u32 s71, s71, 1
    s_cmp_lt_u32 s71, 200000
    s_cbranch_scc0 L_P3_R1_ok
    s_sleep 1
    s_branch L_P3_R1
L_P3_R1_ok:
    s_mul_i32 s52, s28, 15360
    s_add_u32 s52, s52, 0
    v_add_u32 v3, s52, v2
    ds_read_b128 v[8:11], v3 offset:0
    ds_read_b128 v[12:15], v3 offset:1024
    ds_read_b128 v[16:19], v3 offset:2048
    ds_read_b128 v[20:23], v3 offset:3072
    ds_read_b128 v[24:27], v3 offset:4096
    ds_read_b128 v[28:31], v3 offset:5120
    ds_read_b128 v[32:35], v3 offset:6144
    ds_read_b128 v[36:39], v3 offset:7168
    ds_read_b128 v[40:43], v3 offset:8192
    ds_read_b128 v[44:47], v3 offset:9216
    ds_read_b128 v[48:51], v3 offset:10240
    ds_read_b128 v[52:55], v3 offset:11264
    ds_read_b128 v[56:59], v3 offset:12288
    ds_read_b128 v[60:63], v3 offset:13312
    ds_read_b128 v[64:67], v3 offset:14336
    s_lshl_b32 s52, s40, 3
    s_add_u32 s52, s52, s41
    s_lshl_b32 s52, s52, 2
    s_add_u32 s52, s52, s28
    s_mul_i32 s52, s52, 5120
    s_add_u32 s52, s52, 19693568
    s_add_u32 s53, s52, 4096
    s_waitcnt lgkmcnt(0)
    v_mov_b32 v6, 92196
    v_mov_b32 v7, 1
    s_mov_b64 exec, 1
    ds_add_u32 v6, v7
    s_mov_b64 exec, -1
    s_mov_b32 s71, 0
L_P3_R2:
    ds_read_b32 v7, v6
    s_waitcnt lgkmcnt(0)
    v_cmp_gt_u32 vcc, 4, v7
    s_cbranch_vccz L_P3_R2_ok
    s_add_u32 s71, s71, 1
    s_cmp_lt_u32 s71, 200000
    s_cbranch_scc0 L_P3_R2_ok
    s_sleep 1
    s_branch L_P3_R2
L_P3_R2_ok:
    s_mul_i32 s52, s28, 15360
    s_add_u32 s53, s52, s42
    s_add_u32 s53, s53, 245760
    s_add_u32 s52, s52, 0
    s_mov_b32 m0, s52
    s_nop 0
    buffer_load_dwordx4 v2, s[32:35], s53 offen offset:0 lds
    buffer_load_dwordx4 v2, s[32:35], s53 offen offset:1024 lds
    buffer_load_dwordx4 v2, s[32:35], s53 offen offset:2048 lds
    buffer_load_dwordx4 v2, s[32:35], s53 offen offset:3072 lds
    s_add_u32 m0, s52, 4096
    s_add_u32 s54, s53, 4096
    buffer_load_dwordx4 v2, s[32:35], s54 offen lds
    s_add_u32 s52, s52, 5120
    s_add_u32 s53, s53, 5120
    s_mov_b32 m0, s52
    s_nop 0
    buffer_load_dwordx4 v2, s[32:35], s53 offen offset:0 lds
    buffer_load_dwordx4 v2, s[32:35], s53 offen offset:1024 lds
    buffer_load_dwordx4 v2, s[32:35], s53 offen offset:2048 lds
    buffer_load_dwordx4 v2, s[32:35], s53 offen offset:3072 lds
    s_add_u32 m0, s52, 4096
    s_add_u32 s54, s53, 4096
    buffer_load_dwordx4 v2, s[32:35], s54 offen lds
    s_add_u32 s52, s52, 5120
    s_add_u32 s53, s53, 5120
    s_mov_b32 m0, s52
    s_nop 0
    buffer_load_dwordx4 v2, s[32:35], s53 offen offset:0 lds
    buffer_load_dwordx4 v2, s[32:35], s53 offen offset:1024 lds
    buffer_load_dwordx4 v2, s[32:35], s53 offen offset:2048 lds
    buffer_load_dwordx4 v2, s[32:35], s53 offen offset:3072 lds
    s_add_u32 m0, s52, 4096
    s_add_u32 s54, s53, 4096
    buffer_load_dwordx4 v2, s[32:35], s54 offen lds
    s_add_u32 s52, s52, 5120
    s_add_u32 s53, s53, 5120
    s_mov_b32 s48, s4
    s_and_b32 s49, s5, 0xffff
    s_mov_b32 s50, 2621440
    s_mov_b32 s51, 0x00020000
    s_lshl_b32 s53, s40, 6
    s_lshl_b32 s54, s28, 4
    s_add_u32 s53, s53, s54
    s_mul_i32 s53, s53, 1280
    s_mul_i32 s54, s41, 160
    s_add_u32 s47, s53, s54
    v_and_b32 v118, 15, v0
    v_mul_u32_u24 v118, 1280, v118
    v_lshrrev_b32 v119, 4, v0
    v_lshl_add_u32 v118, v119, 3, v118
    buffer_load_dwordx2 v[108:109], v118, s[48:51], s47 offen offset:0
    buffer_load_dwordx2 v[110:111], v118, s[48:51], s47 offen offset:32
    buffer_load_dwordx2 v[112:113], v118, s[48:51], s47 offen offset:64
    buffer_load_dwordx2 v[114:115], v118, s[48:51], s47 offen offset:96
    buffer_load_dwordx2 v[116:117], v118, s[48:51], s47 offen offset:128
    v_add_f32 v88, v88, v8
    v_add_f32 v28, v28, v48
    v_add_f32 v89, v89, v9
    v_add_f32 v29, v29, v49
    v_add_f32 v90, v90, v10
    v_add_f32 v30, v30, v50
    v_add_f32 v91, v91, v11
    v_add_f32 v31, v31, v51
    v_add_f32 v92, v92, v12
    v_add_f32 v32, v32, v52
    v_add_f32 v93, v93, v13
    v_add_f32 v33, v33, v53
    v_add_f32 v94, v94, v14
    v_add_f32 v34, v34, v54
    v_add_f32 v95, v95, v15
    v_add_f32 v35, v35, v55
    v_add_f32 v96, v96, v16
    v_add_f32 v36, v36, v56
    v_add_f32 v97, v97, v17
    v_add_f32 v37, v37, v57
    v_add_f32 v98, v98, v18
    v_add_f32 v38, v38, v58
    v_add_f32 v99, v99, v19
    v_add_f32 v39, v39, v59
    v_add_f32 v100, v100, v20
    v_add_f32 v40, v40, v60
    v_add_f32 v101, v101, v21
    v_add_f32 v41, v41, v61
    v_add_f32 v102, v102, v22
    v_add_f32 v42, v42, v62
    v_add_f32 v103, v103, v23
    v_add_f32 v43, v43, v63
    v_add_f32 v104, v104, v24
    v_add_f32 v44, v44, v64
    v_add_f32 v105, v105, v25
    v_add_f32 v45, v45, v65
    v_add_f32 v106, v106, v26
    v_add_f32 v46, v46, v66
    v_add_f32 v107, v107, v27
    v_add_f32 v47, v47, v67
    v_add_f32 v88, v88, v28
    v_add_f32 v89, v89, v29
    v_add_f32 v90, v90, v30
    v_add_f32 v91, v91, v31
    v_add_f32 v92, v92, v32
    v_add_f32 v93, v93, v33
    v_add_f32 v94, v94, v34
    v_add_f32 v95, v95, v35
    v_add_f32 v96, v96, v36
    v_add_f32 v97, v97, v37
    v_add_f32 v98, v98, v38
    v_add_f32 v99, v99, v39
    v_add_f32 v100, v100, v40
    v_add_f32 v101, v101, v41
    v_add_f32 v102, v102, v42
    v_add_f32 v103, v103, v43
    v_add_f32 v104, v104, v44
    v_add_f32 v105, v105, v45
    v_add_f32 v106, v106, v46
    v_add_f32 v107, v107, v47
    v_mul_f32 v8, 0xbfb8aa3b, v88
    v_mul_f32 v9, 0xbfb8aa3b, v89
    v_mul_f32 v10, 0xbfb8aa3b, v90
    v_mul_f32 v11, 0xbfb8aa3b, v91
    v_mul_f32 v12, 0xbfb8aa3b, v92
    v_mul_f32 v13, 0xbfb8aa3b, v93
    v_mul_f32 v14, 0xbfb8aa3b, v94
    v_mul_f32 v15, 0xbfb8aa3b, v95
    v_mul_f32 v16, 0xbfb8aa3b, v96
    v_mul_f32 v17, 0xbfb8aa3b, v97
    v_mul_f32 v18, 0xbfb8aa3b, v98
    v_mul_f32 v19, 0xbfb8aa3b, v99
    v_mul_f32 v20, 0xbfb8aa3b, v100
    v_mul_f32 v21, 0xbfb8aa3b, v101
    v_mul_f32 v22, 0xbfb8aa3b, v102
    v_mul_f32 v23, 0xbfb8aa3b, v103
    v_mul_f32 v24, 0xbfb8aa3b, v104
    v_mul_f32 v25, 0xbfb8aa3b, v105
    v_mul_f32 v26, 0xbfb8aa3b, v106
    v_mul_f32 v27, 0xbfb8aa3b, v107
    v_exp_f32 v8, v8
    v_exp_f32 v9, v9
    v_exp_f32 v10, v10
    v_exp_f32 v11, v11
    v_exp_f32 v12, v12
    v_exp_f32 v13, v13
    v_exp_f32 v14, v14
    v_exp_f32 v15, v15
    v_exp_f32 v16, v16
    v_exp_f32 v17, v17
    v_exp_f32 v18, v18
    v_exp_f32 v19, v19
    v_exp_f32 v20, v20
    v_exp_f32 v21, v21
    v_exp_f32 v22, v22
    v_exp_f32 v23, v23
    v_exp_f32 v24, v24
    v_exp_f32 v25, v25
    v_exp_f32 v26, v26
    v_exp_f32 v27, v27
    v_add_f32 v8, 1.0, v8
    v_add_f32 v9, 1.0, v9
    v_add_f32 v10, 1.0, v10
    v_add_f32 v11, 1.0, v11
    v_add_f32 v12, 1.0, v12
    v_add_f32 v13, 1.0, v13
    v_add_f32 v14, 1.0, v14
    v_add_f32 v15, 1.0, v15
    v_add_f32 v16, 1.0, v16
    v_add_f32 v17, 1.0, v17
    v_add_f32 v18, 1.0, v18
    v_add_f32 v19, 1.0, v19
    v_add_f32 v20, 1.0, v20
    v_add_f32 v21, 1.0, v21
    v_add_f32 v22, 1.0, v22
    v_add_f32 v23, 1.0, v23
    v_add_f32 v24, 1.0, v24
    v_add_f32 v25, 1.0, v25
    v_add_f32 v26, 1.0, v26
    v_add_f32 v27, 1.0, v27
    v_rcp_f32 v8, v8
    v_rcp_f32 v9, v9
    v_rcp_f32 v10, v10
    v_rcp_f32 v11, v11
    v_rcp_f32 v12, v12
    v_rcp_f32 v13, v13
    v_rcp_f32 v14, v14
    v_rcp_f32 v15, v15
    v_rcp_f32 v16, v16
    v_rcp_f32 v17, v17
    v_rcp_f32 v18, v18
    v_rcp_f32 v19, v19
    v_rcp_f32 v20, v20
    v_rcp_f32 v21, v21
    v_rcp_f32 v22, v22
    v_rcp_f32 v23, v23
    v_rcp_f32 v24, v24
    v_rcp_f32 v25, v25
    v_rcp_f32 v26, v26
    v_rcp_f32 v27, v27
    v_mul_f32 v88, v88, v8
    v_mul_f32 v89, v89, v9
    v_mul_f32 v90, v90, v10
    v_mul_f32 v91, v91, v11
    v_mul_f32 v92, v92, v12
    v_mul_f32 v93, v93, v13
    v_mul_f32 v94, v94, v14
    v_mul_f32 v95, v95, v15
    v_mul_f32 v96, v96, v16
    v_mul_f32 v97, v97, v17
    v_mul_f32 v98, v98, v18
    v_mul_f32 v99, v99, v19
    v_mul_f32 v100, v100, v20
    v_mul_f32 v101, v101, v21
    v_mul_f32 v102, v102, v22
    v_mul_f32 v103, v103, v23
    v_mul_f32 v104, v104, v24
    v_mul_f32 v105, v105, v25
    v_mul_f32 v106, v106, v26
    v_mul_f32 v107, v107, v27
    s_waitcnt vmcnt(0)
    v_mov_b32 v6, 92200
    v_mov_b32 v7, 1
    s_mov_b64 exec, 1
    ds_add_u32 v6, v7
    s_mov_b64 exec, -1
    v_mov_b32 v6, 92200
    s_mov_b32 s71, 0
L_P3_R3:
    ds_read_b32 v7, v6
    s_waitcnt lgkmcnt(0)
    v_cmp_gt_u32 vcc, 4, v7
    s_cbranch_vccz L_P3_R3_ok
    s_add_u32 s71, s71, 1
    s_cmp_lt_u32 s71, 200000
    s_cbranch_scc0 L_P3_R3_ok
    s_sleep 1
    s_branch L_P3_R3
L_P3_R3_ok:
    v_mov_b32 v6, 92208
    s_mov_b32 s71, 0
L_P3_R4:
    ds_read_b32 v7, v6
    s_waitcnt lgkmcnt(0)
    v_cmp_gt_u32 vcc, 8, v7
    s_cbranch_vccz L_P3_R4_ok
    s_add_u32 s71, s71, 1
    s_cmp_lt_u32 s71, 200000
    s_cbranch_scc0 L_P3_R4_ok
    s_sleep 1
    s_branch L_P3_R4
L_P3_R4_ok:
    s_lshl_b32 s52, s40, 2
    s_add_u32 s52, s52, s28
    s_mul_i32 s52, s52, 20480
    s_add_u32 s44, s52, 14286848
    v_add_u32 v3, 92416, v2
    s_mov_b32 s55, 0
    v_bfe_u32 v4, v2, 5, 4
    v_mul_u32_u24 v4, 5, v4
    v_bfe_u32 v5, v2, 4, 1
    v_mul_u32_u24 v5, 3, v5
    v_add_u32 v4, v4, v5
    v_lshlrev_b32 v4, 8, v4
L_P3_PROBE:
    buffer_load_dword v5, v4, s[32:35], s44 offen sc1
    s_waitcnt vmcnt(0)
    v_cmp_eq_u32 vcc, -1, v5
    s_cbranch_vccz L_P3_TRY
    s_add_u32 s55, s55, 1
    s_cmp_lt_u32 s55, 8192
    s_cbranch_scc1 L_P3_PROBE
    s_endpgm
L_P3_TRY:
    s_mov_b32 s45, s44
    buffer_load_dwordx4 v[8:11], v2, s[32:35], s45 offen offset:0 sc1
    buffer_load_dwordx4 v[12:15], v2, s[32:35], s45 offen offset:1024 sc1
    buffer_load_dwordx4 v[16:19], v2, s[32:35], s45 offen offset:2048 sc1
    buffer_load_dwordx4 v[20:23], v2, s[32:35], s45 offen offset:3072 sc1
    s_add_u32 s45, s45, 4096
    buffer_load_dwordx4 v[24:27], v2, s[32:35], s45 offen offset:0 sc1
    buffer_load_dwordx4 v[28:31], v2, s[32:35], s45 offen offset:1024 sc1
    buffer_load_dwordx4 v[32:35], v2, s[32:35], s45 offen offset:2048 sc1
    buffer_load_dwordx4 v[36:39], v2, s[32:35], s45 offen offset:3072 sc1
    s_add_u32 s45, s45, 4096
    buffer_load_dwordx4 v[40:43], v2, s[32:35], s45 offen offset:0 sc1
    buffer_load_dwordx4 v[44:47], v2, s[32:35], s45 offen offset:1024 sc1
    buffer_load_dwordx4 v[48:51], v2, s[32:35], s45 offen offset:2048 sc1
    buffer_load_dwordx4 v[52:55], v2, s[32:35], s45 offen offset:3072 sc1
    s_add_u32 s45, s45, 4096
    buffer_load_dwordx4 v[56:59], v2, s[32:35], s45 offen offset:0 sc1
    buffer_load_dwordx4 v[60:63], v2, s[32:35], s45 offen offset:1024 sc1
    buffer_load_dwordx4 v[64:67], v2, s[32:35], s45 offen offset:2048 sc1
    buffer_load_dwordx4 v[68:71], v2, s[32:35], s45 offen offset:3072 sc1
    s_add_u32 s45, s45, 4096
    buffer_load_dwordx4 v[72:75], v2, s[32:35], s45 offen offset:0 sc1
    buffer_load_dwordx4 v[76:79], v2, s[32:35], s45 offen offset:1024 sc1
    buffer_load_dwordx4 v[80:83], v2, s[32:35], s45 offen offset:2048 sc1
    buffer_load_dwordx4 v[84:87], v2, s[32:35], s45 offen offset:3072 sc1
    v_mov_b32 v120, 0
    v_mov_b32 v121, 0
    v_mov_b32 v122, 0
    v_mov_b32 v123, 0
    v_mov_b32 v124, 0
    v_mov_b32 v125, 0
    v_mov_b32 v126, 0
    v_mov_b32 v127, 0
    v_mov_b32 v128, 0
    v_mov_b32 v129, 0
    v_mov_b32 v130, 0
    v_mov_b32 v131, 0
    v_mov_b32 v132, 0
    v_mov_b32 v133, 0
    v_mov_b32 v134, 0
    v_mov_b32 v135, 0
    v_mov_b32 v136, 0
    v_mov_b32 v137, 0
    v_mov_b32 v138, 0
    v_mov_b32 v139, 0
    ds_read_b128 v[140:143], v2 offset:0
    ds_read_b128 v[144:147], v2 offset:1024
    ds_read_b128 v[148:151], v2 offset:2048
    ds_read_b128 v[152:155], v2 offset:3072
    ds_read_b128 v[156:159], v2 offset:4096
    ds_read_b128 v[160:163], v2 offset:5120
L_P3_CHK0:
    s_waitcnt vmcnt(18)
    v_max3_u32 v4, v8, v9, v10
    v_max3_u32 v5, v11, v12, v13
    v_max3_u32 v4, v4, v14, v15
    v_max_u32 v4, v4, v5
    v_cmp_eq_u32 vcc, -1, v4
    s_cbranch_vccnz L_P3_RETRY0
    s_waitcnt lgkmcnt(5)
    v_mfma_f32_16x16x32_bf16 v[120:123], v[140:143], v[8:11], v[120:123]
    ds_read_b128 v[164:167], v2 offset:6144
    s_waitcnt lgkmcnt(5)
    v_mfma_f32_16x16x32_bf16 v[124:127], v[144:147], v[8:11], v[124:127]
    ds_read_b128 v[140:143], v2 offset:7168
    s_waitcnt lgkmcnt(5)
    v_mfma_f32_16x16x32_bf16 v[128:131], v[148:151], v[8:11], v[128:131]
    ds_read_b128 v[144:147], v2 offset:8192
    s_waitcnt lgkmcnt(5)
    v_mfma_f32_16x16x32_bf16 v[132:135], v[152:155], v[8:11], v[132:135]
    ds_read_b128 v[148:151], v2 offset:9216
    s_waitcnt lgkmcnt(5)
    v_mfma_f32_16x16x32_bf16 v[136:139], v[156:159], v[8:11], v[136:139]
    ds_read_b128 v[152:155], v2 offset:10240
    s_waitcnt lgkmcnt(5)
    v_mfma_f32_16x16x32_bf16 v[120:123], v[160:163], v[12:15], v[120:123]
    ds_read_b128 v[156:159], v2 offset:11264
    s_waitcnt lgkmcnt(5)
    v_mfma_f32_16x16x32_bf16 v[124:127], v[164:167], v[12:15], v[124:127]
    ds_read_b128 v[160:163], v2 offset:12288
L_P3_CHK1:
    s_waitcnt vmcnt(16)
    v_max3_u32 v4, v16, v17, v18
    v_max3_u32 v5, v19, v20, v21
    v_max3_u32 v4, v4, v22, v23
    v_max_u32 v4, v4, v5
    v_cmp_eq_u32 vcc, -1, v4
    s_cbranch_vccnz L_P3_RETRY1
    s_waitcnt lgkmcnt(5)
    v_mfma_f32_16x16x32_bf16 v[128:131], v[140:143], v[12:15], v[128:131]
    ds_read_b128 v[164:167], v2 offset:13312
    s_waitcnt lgkmcnt(5)
    v_mfma_f32_16x16x32_bf16 v[132:135], v[144:147], v[12:15], v[132:135]
    ds_read_b128 v[140:143], v2 offset:14336
    s_waitcnt lgkmcnt(5)
    v_mfma_f32_16x16x32_bf16 v[136:139], v[148:151], v[12:15], v[136:139]
    ds_read_b128 v[144:147], v2 offset:15360
    s_waitcnt lgkmcnt(5)
    v_mfma_f32_16x16x32_bf16 v[120:123], v[152:155], v[16:19], v[120:123]
    ds_read_b128 v[148:151], v2 offset:16384
    s_waitcnt lgkmcnt(5)
    v_mfma_f32_16x16x32_bf16 v[124:127], v[156:159], v[16:19], v[124:127]
    ds_read_b128 v[152:155], v2 offset:17408
    s_waitcnt lgkmcnt(5)
    v_mfma_f32_16x16x32_bf16 v[128:131], v[160:163], v[16:19], v[128:131]
    ds_read_b128 v[156:159], v2 offset:18432
    s_waitcnt lgkmcnt(5)
    v_mfma_f32_16x16x32_bf16 v[132:135], v[164:167], v[16:19], v[132:135]
    ds_read_b128 v[160:163], v2 offset:19456
    s_waitcnt lgkmcnt(5)
    v_mfma_f32_16x16x32_bf16 v[136:139], v[140:143], v[16:19], v[136:139]
    ds_read_b128 v[164:167], v2 offset:20480
    s_waitcnt lgkmcnt(5)
    v_mfma_f32_16x16x32_bf16 v[120:123], v[144:147], v[20:23], v[120:123]
    ds_read_b128 v[140:143], v2 offset:21504
    s_waitcnt lgkmcnt(5)
    v_mfma_f32_16x16x32_bf16 v[124:127], v[148:151], v[20:23], v[124:127]
    ds_read_b128 v[144:147], v2 offset:22528
L_P3_CHK2:
    s_waitcnt vmcnt(14)
    v_max3_u32 v4, v24, v25, v26
    v_max3_u32 v5, v27, v28, v29
    v_max3_u32 v4, v4, v30, v31
    v_max_u32 v4, v4, v5
    v_cmp_eq_u32 vcc, -1, v4
    s_cbranch_vccnz L_P3_RETRY2
    s_waitcnt lgkmcnt(5)
    v_mfma_f32_16x16x32_bf16 v[128:131], v[152:155], v[20:23], v[128:131]
    ds_read_b128 v[148:151], v2 offset:23552
    s_waitcnt lgkmcnt(5)
    v_mfma_f32_16x16x32_bf16 v[132:135], v[156:159], v[20:23], v[132:135]
    ds_read_b128 v[152:155], v2 offset:24576
    s_waitcnt lgkmcnt(5)
    v_mfma_f32_16x16x32_bf16 v[136:139], v[160:163], v[20:23], v[136:139]
    ds_read_b128 v[156:159], v2 offset:25600
    s_waitcnt lgkmcnt(5)
    v_mfma_f32_16x16x32_bf16 v[120:123], v[164:167], v[24:27], v[120:123]
    ds_read_b128 v[160:163], v2 offset:26624
    s_waitcnt lgkmcnt(5)
    v_mfma_f32_16x16x32_bf16 v[124:127], v[140:143], v[24:27], v[124:127]
    ds_read_b128 v[164:167], v2 offset:27648
    s_waitcnt lgkmcnt(5)
    v_mfma_f32_16x16x32_bf16 v[128:131], v[144:147], v[24:27], v[128:131]
    ds_read_b128 v[140:143], v2 offset:28672
    s_waitcnt lgkmcnt(5)
    v_mfma_f32_16x16x32_bf16 v[132:135], v[148:151], v[24:27], v[132:135]
    ds_read_b128 v[144:147], v2 offset:29696
    s_waitcnt lgkmcnt(5)
    v_mfma_f32_16x16x32_bf16 v[136:139], v[152:155], v[24:27], v[136:139]
    ds_read_b128 v[148:151], v2 offset:30720
    s_waitcnt lgkmcnt(5)
    v_mfma_f32_16x16x32_bf16 v[120:123], v[156:159], v[28:31], v[120:123]
    ds_read_b128 v[152:155], v2 offset:31744
    s_waitcnt lgkmcnt(5)
    v_mfma_f32_16x16x32_bf16 v[124:127], v[160:163], v[28:31], v[124:127]
    ds_read_b128 v[156:159], v2 offset:32768
L_P3_CHK3:
    s_waitcnt vmcnt(12)
    v_max3_u32 v4, v32, v33, v34
    v_max3_u32 v5, v35, v36, v37
    v_max3_u32 v4, v4, v38, v39
    v_max_u32 v4, v4, v5
    v_cmp_eq_u32 vcc, -1, v4
    s_cbranch_vccnz L_P3_RETRY3
    s_waitcnt lgkmcnt(5)
    v_mfma_f32_16x16x32_bf16 v[128:131], v[164:167], v[28:31], v[128:131]
    ds_read_b128 v[160:163], v2 offset:33792
    s_waitcnt lgkmcnt(5)
    v_mfma_f32_16x16x32_bf16 v[132:135], v[140:143], v[28:31], v[132:135]
    ds_read_b128 v[164:167], v2 offset:34816
    s_waitcnt lgkmcnt(5)
    v_mfma_f32_16x16x32_bf16 v[136:139], v[144:147], v[28:31], v[136:139]
    ds_read_b128 v[140:143], v2 offset:35840
    s_waitcnt lgkmcnt(5)
    v_mfma_f32_16x16x32_bf16 v[120:123], v[148:151], v[32:35], v[120:123]
    ds_read_b128 v[144:147], v2 offset:36864
    s_waitcnt lgkmcnt(5)
    v_mfma_f32_16x16x32_bf16 v[124:127], v[152:155], v[32:35], v[124:127]
    ds_read_b128 v[148:151], v2 offset:37888
    s_waitcnt lgkmcnt(5)
    v_mfma_f32_16x16x32_bf16 v[128:131], v[156:159], v[32:35], v[128:131]
    ds_read_b128 v[152:155], v2 offset:38912
    s_waitcnt lgkmcnt(5)
    v_mfma_f32_16x16x32_bf16 v[132:135], v[160:163], v[32:35], v[132:135]
    ds_read_b128 v[156:159], v2 offset:39936
    s_waitcnt lgkmcnt(5)
    v_mfma_f32_16x16x32_bf16 v[136:139], v[164:167], v[32:35], v[136:139]
    ds_read_b128 v[160:163], v2 offset:40960
    s_waitcnt lgkmcnt(5)
    v_mfma_f32_16x16x32_bf16 v[120:123], v[140:143], v[36:39], v[120:123]
    ds_read_b128 v[164:167], v2 offset:41984
    s_waitcnt lgkmcnt(5)
    v_mfma_f32_16x16x32_bf16 v[124:127], v[144:147], v[36:39], v[124:127]
    ds_read_b128 v[140:143], v2 offset:43008
L_P3_CHK4:
    s_waitcnt vmcnt(10)
    v_max3_u32 v4, v40, v41, v42
    v_max3_u32 v5, v43, v44, v45
    v_max3_u32 v4, v4, v46, v47
    v_max_u32 v4, v4, v5
    v_cmp_eq_u32 vcc, -1, v4
    s_cbranch_vccnz L_P3_RETRY4
    s_waitcnt lgkmcnt(5)
    v_mfma_f32_16x16x32_bf16 v[128:131], v[148:151], v[36:39], v[128:131]
    ds_read_b128 v[144:147], v2 offset:44032
    s_waitcnt lgkmcnt(5)
    v_mfma_f32_16x16x32_bf16 v[132:135], v[152:155], v[36:39], v[132:135]
    ds_read_b128 v[148:151], v2 offset:45056
    s_waitcnt lgkmcnt(5)
    v_mfma_f32_16x16x32_bf16 v[136:139], v[156:159], v[36:39], v[136:139]
    ds_read_b128 v[152:155], v2 offset:46080
    s_waitcnt lgkmcnt(5)
    v_mfma_f32_16x16x32_bf16 v[120:123], v[160:163], v[40:43], v[120:123]
    ds_read_b128 v[156:159], v2 offset:47104
    s_waitcnt lgkmcnt(5)
    v_mfma_f32_16x16x32_bf16 v[124:127], v[164:167], v[40:43], v[124:127]
    ds_read_b128 v[160:163], v2 offset:48128
    s_waitcnt lgkmcnt(5)
    v_mfma_f32_16x16x32_bf16 v[128:131], v[140:143], v[40:43], v[128:131]
    ds_read_b128 v[164:167], v2 offset:49152
    s_waitcnt lgkmcnt(5)
    v_mfma_f32_16x16x32_bf16 v[132:135], v[144:147], v[40:43], v[132:135]
    ds_read_b128 v[140:143], v2 offset:50176
    s_waitcnt lgkmcnt(5)
    v_mfma_f32_16x16x32_bf16 v[136:139], v[148:151], v[40:43], v[136:139]
    ds_read_b128 v[144:147], v2 offset:51200
    s_waitcnt lgkmcnt(5)
    v_mfma_f32_16x16x32_bf16 v[120:123], v[152:155], v[44:47], v[120:123]
    ds_read_b128 v[148:151], v2 offset:52224
    s_waitcnt lgkmcnt(5)
    v_mfma_f32_16x16x32_bf16 v[124:127], v[156:159], v[44:47], v[124:127]
    ds_read_b128 v[152:155], v2 offset:53248
L_P3_CHK5:
    s_waitcnt vmcnt(8)
    v_max3_u32 v4, v48, v49, v50
    v_max3_u32 v5, v51, v52, v53
    v_max3_u32 v4, v4, v54, v55
    v_max_u32 v4, v4, v5
    v_cmp_eq_u32 vcc, -1, v4
    s_cbranch_vccnz L_P3_RETRY5
    s_waitcnt lgkmcnt(5)
    v_mfma_f32_16x16x32_bf16 v[128:131], v[160:163], v[44:47], v[128:131]
    ds_read_b128 v[156:159], v2 offset:54272
    s_waitcnt lgkmcnt(5)
    v_mfma_f32_16x16x32_bf16 v[132:135], v[164:167], v[44:47], v[132:135]
    ds_read_b128 v[160:163], v2 offset:55296
    s_waitcnt lgkmcnt(5)
    v_mfma_f32_16x16x32_bf16 v[136:139], v[140:143], v[44:47], v[136:139]
    ds_read_b128 v[164:167], v2 offset:56320
    s_waitcnt lgkmcnt(5)
    v_mfma_f32_16x16x32_bf16 v[120:123], v[144:147], v[48:51], v[120:123]
    ds_read_b128 v[140:143], v2 offset:57344
    s_waitcnt lgkmcnt(5)
    v_mfma_f32_16x16x32_bf16 v[124:127], v[148:151], v[48:51], v[124:127]
    ds_read_b128 v[144:147], v2 offset:58368
    s_waitcnt lgkmcnt(5)
    v_mfma_f32_16x16x32_bf16 v[128:131], v[152:155], v[48:51], v[128:131]
    ds_read_b128 v[148:151], v2 offset:59392
    s_waitcnt lgkmcnt(5)
    v_mfma_f32_16x16x32_bf16 v[132:135], v[156:159], v[48:51], v[132:135]
    ds_read_b128 v[152:155], v2 offset:60416
    s_waitcnt lgkmcnt(5)
    v_mfma_f32_16x16x32_bf16 v[136:139], v[160:163], v[48:51], v[136:139]
    ds_read_b128 v[156:159], v3 offset:0
    s_waitcnt lgkmcnt(5)
    v_mfma_f32_16x16x32_bf16 v[120:123], v[164:167], v[52:55], v[120:123]
    ds_read_b128 v[160:163], v3 offset:1024
    s_waitcnt lgkmcnt(5)
    v_mfma_f32_16x16x32_bf16 v[124:127], v[140:143], v[52:55], v[124:127]
    ds_read_b128 v[164:167], v3 offset:2048
L_P3_CHK6:
    s_waitcnt vmcnt(6)
    v_max3_u32 v4, v56, v57, v58
    v_max3_u32 v5, v59, v60, v61
    v_max3_u32 v4, v4, v62, v63
    v_max_u32 v4, v4, v5
    v_cmp_eq_u32 vcc, -1, v4
    s_cbranch_vccnz L_P3_RETRY6
    s_waitcnt lgkmcnt(5)
    v_mfma_f32_16x16x32_bf16 v[128:131], v[144:147], v[52:55], v[128:131]
    ds_read_b128 v[140:143], v3 offset:3072
    s_waitcnt lgkmcnt(5)
    v_mfma_f32_16x16x32_bf16 v[132:135], v[148:151], v[52:55], v[132:135]
    ds_read_b128 v[144:147], v3 offset:4096
    s_waitcnt lgkmcnt(5)
    v_mfma_f32_16x16x32_bf16 v[136:139], v[152:155], v[52:55], v[136:139]
    ds_read_b128 v[148:151], v3 offset:5120
    s_waitcnt lgkmcnt(5)
    v_mfma_f32_16x16x32_bf16 v[120:123], v[156:159], v[56:59], v[120:123]
    ds_read_b128 v[152:155], v3 offset:6144
    s_waitcnt lgkmcnt(5)
    v_mfma_f32_16x16x32_bf16 v[124:127], v[160:163], v[56:59], v[124:127]
    ds_read_b128 v[156:159], v3 offset:7168
    s_waitcnt lgkmcnt(5)
    v_mfma_f32_16x16x32_bf16 v[128:131], v[164:167], v[56:59], v[128:131]
    ds_read_b128 v[160:163], v3 offset:8192
    s_waitcnt lgkmcnt(5)
    v_mfma_f32_16x16x32_bf16 v[132:135], v[140:143], v[56:59], v[132:135]
    ds_read_b128 v[164:167], v3 offset:9216
    s_waitcnt lgkmcnt(5)
    v_mfma_f32_16x16x32_bf16 v[136:139], v[144:147], v[56:59], v[136:139]
    ds_read_b128 v[140:143], v3 offset:10240
    s_waitcnt lgkmcnt(5)
    v_mfma_f32_16x16x32_bf16 v[120:123], v[148:151], v[60:63], v[120:123]
    ds_read_b128 v[144:147], v3 offset:11264
    s_waitcnt lgkmcnt(5)
    v_mfma_f32_16x16x32_bf16 v[124:127], v[152:155], v[60:63], v[124:127]
    ds_read_b128 v[148:151], v3 offset:12288
L_P3_CHK7:
    s_waitcnt vmcnt(4)
    v_max3_u32 v4, v64, v65, v66
    v_max3_u32 v5, v67, v68, v69
    v_max3_u32 v4, v4, v70, v71
    v_max_u32 v4, v4, v5
    v_cmp_eq_u32 vcc, -1, v4
    s_cbranch_vccnz L_P3_RETRY7
    s_waitcnt lgkmcnt(5)
    v_mfma_f32_16x16x32_bf16 v[128:131], v[156:159], v[60:63], v[128:131]
    ds_read_b128 v[152:155], v3 offset:13312
    s_waitcnt lgkmcnt(5)
    v_mfma_f32_16x16x32_bf16 v[132:135], v[160:163], v[60:63], v[132:135]
    ds_read_b128 v[156:159], v3 offset:14336
    s_waitcnt lgkmcnt(5)
    v_mfma_f32_16x16x32_bf16 v[136:139], v[164:167], v[60:63], v[136:139]
    ds_read_b128 v[160:163], v3 offset:15360
    s_waitcnt lgkmcnt(5)
    v_mfma_f32_16x16x32_bf16 v[120:123], v[140:143], v[64:67], v[120:123]
    ds_read_b128 v[164:167], v3 offset:16384
    s_waitcnt lgkmcnt(5)
    v_mfma_f32_16x16x32_bf16 v[124:127], v[144:147], v[64:67], v[124:127]
    ds_read_b128 v[140:143], v3 offset:17408
    s_waitcnt lgkmcnt(5)
    v_mfma_f32_16x16x32_bf16 v[128:131], v[148:151], v[64:67], v[128:131]
    ds_read_b128 v[144:147], v3 offset:18432
    s_waitcnt lgkmcnt(5)
    v_mfma_f32_16x16x32_bf16 v[132:135], v[152:155], v[64:67], v[132:135]
    ds_read_b128 v[148:151], v3 offset:19456
    s_waitcnt lgkmcnt(5)
    v_mfma_f32_16x16x32_bf16 v[136:139], v[156:159], v[64:67], v[136:139]
    ds_read_b128 v[152:155], v3 offset:20480
    s_waitcnt lgkmcnt(5)
    v_mfma_f32_16x16x32_bf16 v[120:123], v[160:163], v[68:71], v[120:123]
    ds_read_b128 v[156:159], v3 offset:21504
    s_waitcnt lgkmcnt(5)
    v_mfma_f32_16x16x32_bf16 v[124:127], v[164:167], v[68:71], v[124:127]
    ds_read_b128 v[160:163], v3 offset:22528
L_P3_CHK8:
    s_waitcnt vmcnt(2)
    v_max3_u32 v4, v72, v73, v74
    v_max3_u32 v5, v75, v76, v77
    v_max3_u32 v4, v4, v78, v79
    v_max_u32 v4, v4, v5
    v_cmp_eq_u32 vcc, -1, v4
    s_cbranch_vccnz L_P3_RETRY8
    s_waitcnt lgkmcnt(5)
    v_mfma_f32_16x16x32_bf16 v[128:131], v[140:143], v[68:71], v[128:131]
    ds_read_b128 v[164:167], v3 offset:23552
    s_waitcnt lgkmcnt(5)
    v_mfma_f32_16x16x32_bf16 v[132:135], v[144:147], v[68:71], v[132:135]
    ds_read_b128 v[140:143], v3 offset:24576
    s_waitcnt lgkmcnt(5)
    v_mfma_f32_16x16x32_bf16 v[136:139], v[148:151], v[68:71], v[136:139]
    ds_read_b128 v[144:147], v3 offset:25600
    s_waitcnt lgkmcnt(5)
    v_mfma_f32_16x16x32_bf16 v[120:123], v[152:155], v[72:75], v[120:123]
    ds_read_b128 v[148:151], v3 offset:26624
    s_waitcnt lgkmcnt(5)
    v_mfma_f32_16x16x32_bf16 v[124:127], v[156:159], v[72:75], v[124:127]
    ds_read_b128 v[152:155], v3 offset:27648
    s_waitcnt lgkmcnt(5)
    v_mfma_f32_16x16x32_bf16 v[128:131], v[160:163], v[72:75], v[128:131]
    ds_read_b128 v[156:159], v3 offset:28672
    s_waitcnt lgkmcnt(5)
    v_mfma_f32_16x16x32_bf16 v[132:135], v[164:167], v[72:75], v[132:135]
    ds_read_b128 v[160:163], v3 offset:29696
    s_waitcnt lgkmcnt(5)
    v_mfma_f32_16x16x32_bf16 v[136:139], v[140:143], v[72:75], v[136:139]
    ds_read_b128 v[164:167], v3 offset:30720
    s_waitcnt lgkmcnt(5)
    v_mfma_f32_16x16x32_bf16 v[120:123], v[144:147], v[76:79], v[120:123]
    ds_read_b128 v[140:143], v3 offset:31744
    s_waitcnt lgkmcnt(5)
    v_mfma_f32_16x16x32_bf16 v[124:127], v[148:151], v[76:79], v[124:127]
    ds_read_b128 v[144:147], v3 offset:32768
L_P3_CHK9:
    s_waitcnt vmcnt(0)
    v_max3_u32 v4, v80, v81, v82
    v_max3_u32 v5, v83, v84, v85
    v_max3_u32 v4, v4, v86, v87
    v_max_u32 v4, v4, v5
    v_cmp_eq_u32 vcc, -1, v4
    s_cbranch_vccnz L_P3_RETRY9
    s_waitcnt lgkmcnt(5)
    v_mfma_f32_16x16x32_bf16 v[128:131], v[152:155], v[76:79], v[128:131]
    ds_read_b128 v[148:151], v3 offset:33792
    s_waitcnt lgkmcnt(5)
    v_mfma_f32_16x16x32_bf16 v[132:135], v[156:159], v[76:79], v[132:135]
    ds_read_b128 v[152:155], v3 offset:34816
    s_waitcnt lgkmcnt(5)
    v_mfma_f32_16x16x32_bf16 v[136:139], v[160:163], v[76:79], v[136:139]
    ds_read_b128 v[156:159], v3 offset:35840
    s_waitcnt lgkmcnt(5)
    v_mfma_f32_16x16x32_bf16 v[120:123], v[164:167], v[80:83], v[120:123]
    ds_read_b128 v[160:163], v3 offset:36864
    s_waitcnt lgkmcnt(5)
    v_mfma_f32_16x16x32_bf16 v[124:127], v[140:143], v[80:83], v[124:127]
    ds_read_b128 v[164:167], v3 offset:37888
    s_waitcnt lgkmcnt(5)
    v_mfma_f32_16x16x32_bf16 v[128:131], v[144:147], v[80:83], v[128:131]
    ds_read_b128 v[140:143], v3 offset:38912
    s_waitcnt lgkmcnt(5)
    v_mfma_f32_16x16x32_bf16 v[132:135], v[148:151], v[80:83], v[132:135]
    ds_read_b128 v[144:147], v3 offset:39936
    s_waitcnt lgkmcnt(5)
    v_mfma_f32_16x16x32_bf16 v[136:139], v[152:155], v[80:83], v[136:139]
    s_waitcnt lgkmcnt(4)
    v_mfma_f32_16x16x32_bf16 v[120:123], v[156:159], v[84:87], v[120:123]
    s_waitcnt lgkmcnt(3)
    v_mfma_f32_16x16x32_bf16 v[124:127], v[160:163], v[84:87], v[124:127]
    s_waitcnt lgkmcnt(2)
    v_mfma_f32_16x16x32_bf16 v[128:131], v[164:167], v[84:87], v[128:131]
    s_waitcnt lgkmcnt(1)
    v_mfma_f32_16x16x32_bf16 v[132:135], v[140:143], v[84:87], v[132:135]
    s_waitcnt lgkmcnt(0)
    v_mfma_f32_16x16x32_bf16 v[136:139], v[144:147], v[84:87], v[136:139]
    s_mov_b32 s48, s18
    s_and_b32 s49, s19, 0xffff
    s_mov_b32 s50, 2621440
    s_mov_b32 s51, 0x00020000
    v_lshlrev_b32 v8, 16, v108
    v_and_b32 v9, 0xffff0000, v108
    v_lshlrev_b32 v10, 16, v109
    v_and_b32 v11, 0xffff0000, v109
    v_lshlrev_b32 v12, 16, v110
    v_and_b32 v13, 0xffff0000, v110
    v_lshlrev_b32 v14, 16, v111
    v_and_b32 v15, 0xffff0000, v111
    v_lshlrev_b32 v16, 16, v112
    v_and_b32 v17, 0xffff0000, v112
    v_lshlrev_b32 v18, 16, v113
    v_and_b32 v19, 0xffff0000, v113
    v_lshlrev_b32 v20, 16, v114
    v_and_b32 v21, 0xffff0000, v114
    v_lshlrev_b32 v22, 16, v115
    v_and_b32 v23, 0xffff0000, v115
    v_lshlrev_b32 v24, 16, v116
    v_and_b32 v25, 0xffff0000, v116
    v_lshlrev_b32 v26, 16, v117
    v_and_b32 v27, 0xffff0000, v117
    s_nop 7
    v_fma_f32 v8, v120, v88, v8
    v_fma_f32 v9, v121, v89, v9
    v_fma_f32 v10, v122, v90, v10
    v_fma_f32 v11, v123, v91, v11
    v_fma_f32 v12, v124, v92, v12
    v_fma_f32 v13, v125, v93, v13
    v_fma_f32 v14, v126, v94, v14
    v_fma_f32 v15, v127, v95, v15
    v_fma_f32 v16, v128, v96, v16
    v_fma_f32 v17, v129, v97, v17
    v_fma_f32 v18, v130, v98, v18
    v_fma_f32 v19, v131, v99, v19
    v_fma_f32 v20, v132, v100, v20
    v_fma_f32 v21, v133, v101, v21
    v_fma_f32 v22, v134, v102, v22
    v_fma_f32 v23, v135, v103, v23
    v_fma_f32 v24, v136, v104, v24
    v_fma_f32 v25, v137, v105, v25
    v_fma_f32 v26, v138, v106, v26
    v_fma_f32 v27, v139, v107, v27
    v_cvt_pk_bf16_f32 v28, v8, v9
    v_cvt_pk_bf16_f32 v29, v10, v11
    v_cvt_pk_bf16_f32 v30, v12, v13
    v_cvt_pk_bf16_f32 v31, v14, v15
    v_cvt_pk_bf16_f32 v32, v16, v17
    v_cvt_pk_bf16_f32 v33, v18, v19
    v_cvt_pk_bf16_f32 v34, v20, v21
    v_cvt_pk_bf16_f32 v35, v22, v23
    v_cvt_pk_bf16_f32 v36, v24, v25
    v_cvt_pk_bf16_f32 v37, v26, v27
    buffer_store_dwordx2 v[28:29], v118, s[48:51], s47 offen offset:0
    buffer_store_dwordx2 v[30:31], v118, s[48:51], s47 offen offset:32
    buffer_store_dwordx2 v[32:33], v118, s[48:51], s47 offen offset:64
    buffer_store_dwordx2 v[34:35], v118, s[48:51], s47 offen offset:96
    buffer_store_dwordx2 v[36:37], v118, s[48:51], s47 offen offset:128
L_K2_END:
    s_endpgm
L_P3_RETRY0:
    s_add_u32 s55, s55, 1
    s_cmp_lt_u32 s55, 8192
    s_cbranch_scc0 L_P3_GIVEUP
    s_add_u32 s45, s44, 0
    buffer_load_dwordx4 v[8:11], v2, s[32:35], s45 offen offset:0 sc1
    buffer_load_dwordx4 v[12:15], v2, s[32:35], s45 offen offset:1024 sc1
    buffer_load_dwordx4 v[16:19], v2, s[32:35], s45 offen offset:2048 sc1
    buffer_load_dwordx4 v[20:23], v2, s[32:35], s45 offen offset:3072 sc1
    s_add_u32 s45, s45, 4096
    buffer_load_dwordx4 v[24:27], v2, s[32:35], s45 offen offset:0 sc1
    buffer_load_dwordx4 v[28:31], v2, s[32:35], s45 offen offset:1024 sc1
    buffer_load_dwordx4 v[32:35], v2, s[32:35], s45 offen offset:2048 sc1
    buffer_load_dwordx4 v[36:39], v2, s[32:35], s45 offen offset:3072 sc1
    s_add_u32 s45, s45, 4096
    buffer_load_dwordx4 v[40:43], v2, s[32:35], s45 offen offset:0 sc1
    buffer_load_dwordx4 v[44:47], v2, s[32:35], s45 offen offset:1024 sc1
    buffer_load_dwordx4 v[48:51], v2, s[32:35], s45 offen offset:2048 sc1
    buffer_load_dwordx4 v[52:55], v2, s[32:35], s45 offen offset:3072 sc1
    s_add_u32 s45, s45, 4096
    buffer_load_dwordx4 v[56:59], v2, s[32:35], s45 offen offset:0 sc1
    buffer_load_dwordx4 v[60:63], v2, s[32:35], s45 offen offset:1024 sc1
    buffer_load_dwordx4 v[64:67], v2, s[32:35], s45 offen offset:2048 sc1
    buffer_load_dwordx4 v[68:71], v2, s[32:35], s45 offen offset:3072 sc1
    s_add_u32 s45, s45, 4096
    buffer_load_dwordx4 v[72:75], v2, s[32:35], s45 offen offset:0 sc1
    buffer_load_dwordx4 v[76:79], v2, s[32:35], s45 offen offset:1024 sc1
    buffer_load_dwordx4 v[80:83], v2, s[32:35], s45 offen offset:2048 sc1
    buffer_load_dwordx4 v[84:87], v2, s[32:35], s45 offen offset:3072 sc1
    s_branch L_P3_CHK0
L_P3_RETRY1:
    s_add_u32 s55, s55, 1
    s_cmp_lt_u32 s55, 8192
    s_cbranch_scc0 L_P3_GIVEUP
    s_add_u32 s45, s44, 0
    buffer_load_dwordx4 v[16:19], v2, s[32:35], s45 offen offset:2048 sc1
    buffer_load_dwordx4 v[20:23], v2, s[32:35], s45 offen offset:3072 sc1
    s_add_u32 s45, s45, 4096
    buffer_load_dwordx4 v[24:27], v2, s[32:35], s45 offen offset:0 sc1
    buffer_load_dwordx4 v[28:31], v2, s[32:35], s45 offen offset:1024 sc1
    buffer_load_dwordx4 v[32:35], v2, s[32:35], s45 offen offset:2048 sc1
    buffer_load_dwordx4 v[36:39], v2, s[32:35], s45 offen offset:3072 sc1
    s_add_u32 s45, s45, 4096
    buffer_load_dwordx4 v[40:43], v2, s[32:35], s45 offen offset:0 sc1
    buffer_load_dwordx4 v[44:47], v2, s[32:35], s45 offen offset:1024 sc1
    buffer_load_dwordx4 v[48:51], v2, s[32:35], s45 offen offset:2048 sc1
    buffer_load_dwordx4 v[52:55], v2, s[32:35], s45 offen offset:3072 sc1
    s_add_u32 s45, s45, 4096
    buffer_load_dwordx4 v[56:59], v2, s[32:35], s45 offen offset:0 sc1
    buffer_load_dwordx4 v[60:63], v2, s[32:35], s45 offen offset:1024 sc1
    buffer_load_dwordx4 v[64:67], v2, s[32:35], s45 offen offset:2048 sc1
    buffer_load_dwordx4 v[68:71], v2, s[32:35], s45 offen offset:3072 sc1
    s_add_u32 s45, s45, 4096
    buffer_load_dwordx4 v[72:75], v2, s[32:35], s45 offen offset:0 sc1
    buffer_load_dwordx4 v[76:79], v2, s[32:35], s45 offen offset:1024 sc1
    buffer_load_dwordx4 v[80:83], v2, s[32:35], s45 offen offset:2048 sc1
    buffer_load_dwordx4 v[84:87], v2, s[32:35], s45 offen offset:3072 sc1
    s_branch L_P3_CHK1
L_P3_RETRY2:
    s_add_u32 s55, s55, 1
    s_cmp_lt_u32 s55, 8192
    s_cbranch_scc0 L_P3_GIVEUP
    s_add_u32 s45, s44, 4096
    buffer_load_dwordx4 v[24:27], v2, s[32:35], s45 offen offset:0 sc1
    buffer_load_dwordx4 v[28:31], v2, s[32:35], s45 offen offset:1024 sc1
    buffer_load_dwordx4 v[32:35], v2, s[32:35], s45 offen offset:2048 sc1
    buffer_load_dwordx4 v[36:39], v2, s[32:35], s45 offen offset:3072 sc1
    s_add_u32 s45, s45, 4096
    buffer_load_dwordx4 v[40:43], v2, s[32:35], s45 offen offset:0 sc1
    buffer_load_dwordx4 v[44:47], v2, s[32:35], s45 offen offset:1024 sc1
    buffer_load_dwordx4 v[48:51], v2, s[32:35], s45 offen offset:2048 sc1
    buffer_load_dwordx4 v[52:55], v2, s[32:35], s45 offen offset:3072 sc1
    s_add_u32 s45, s45, 4096
    buffer_load_dwordx4 v[56:59], v2, s[32:35], s45 offen offset:0 sc1
    buffer_load_dwordx4 v[60:63], v2, s[32:35], s45 offen offset:1024 sc1
    buffer_load_dwordx4 v[64:67], v2, s[32:35], s45 offen offset:2048 sc1
    buffer_load_dwordx4 v[68:71], v2, s[32:35], s45 offen offset:3072 sc1
    s_add_u32 s45, s45, 4096
    buffer_load_dwordx4 v[72:75], v2, s[32:35], s45 offen offset:0 sc1
    buffer_load_dwordx4 v[76:79], v2, s[32:35], s45 offen offset:1024 sc1
    buffer_load_dwordx4 v[80:83], v2, s[32:35], s45 offen offset:2048 sc1
    buffer_load_dwordx4 v[84:87], v2, s[32:35], s45 offen offset:3072 sc1
    s_branch L_P3_CHK2
L_P3_RETRY3:
    s_add_u32 s55, s55, 1
    s_cmp_lt_u32 s55, 8192
    s_cbranch_scc0 L_P3_GIVEUP
    s_add_u32 s45, s44, 4096
    buffer_load_dwordx4 v[32:35], v2, s[32:35], s45 offen offset:2048 sc1
    buffer_load_dwordx4 v[36:39], v2, s[32:35], s45 offen offset:3072 sc1
    s_add_u32 s45, s45, 4096
    buffer_load_dwordx4 v[40:43], v2, s[32:35], s45 offen offset:0 sc1
    buffer_load_dwordx4 v[44:47], v2, s[32:35], s45 offen offset:1024 sc1
    buffer_load_dwordx4 v[48:51], v2, s[32:35], s45 offen offset:2048 sc1
    buffer_load_dwordx4 v[52:55], v2, s[32:35], s45 offen offset:3072 sc1
    s_add_u32 s45, s45, 4096
    buffer_load_dwordx4 v[56:59], v2, s[32:35], s45 offen offset:0 sc1
    buffer_load_dwordx4 v[60:63], v2, s[32:35], s45 offen offset:1024 sc1
    buffer_load_dwordx4 v[64:67], v2, s[32:35], s45 offen offset:2048 sc1
    buffer_load_dwordx4 v[68:71], v2, s[32:35], s45 offen offset:3072 sc1
    s_add_u32 s45, s45, 4096
    buffer_load_dwordx4 v[72:75], v2, s[32:35], s45 offen offset:0 sc1
    buffer_load_dwordx4 v[76:79], v2, s[32:35], s45 offen offset:1024 sc1
    buffer_load_dwordx4 v[80:83], v2, s[32:35], s45 offen offset:2048 sc1
    buffer_load_dwordx4 v[84:87], v2, s[32:35], s45 offen offset:3072 sc1
    s_branch L_P3_CHK3
L_P3_RETRY4:
    s_add_u32 s55, s55, 1
    s_cmp_lt_u32 s55, 8192
    s_cbranch_scc0 L_P3_GIVEUP
    s_add_u32 s45, s44, 8192
    buffer_load_dwordx4 v[40:43], v2, s[32:35], s45 offen offset:0 sc1
    buffer_load_dwordx4 v[44:47], v2, s[32:35], s45 offen offset:1024 sc1
    buffer_load_dwordx4 v[48:51], v2, s[32:35], s45 offen offset:2048 sc1
    buffer_load_dwordx4 v[52:55], v2, s[32:35], s45 offen offset:3072 sc1
    s_add_u32 s45, s45, 4096
    buffer_load_dwordx4 v[56:59], v2, s[32:35], s45 offen offset:0 sc1
    buffer_load_dwordx4 v[60:63], v2, s[32:35], s45 offen offset:1024 sc1
    buffer_load_dwordx4 v[64:67], v2, s[32:35], s45 offen offset:2048 sc1
    buffer_load_dwordx4 v[68:71], v2, s[32:35], s45 offen offset:3072 sc1
    s_add_u32 s45, s45, 4096
    buffer_load_dwordx4 v[72:75], v2, s[32:35], s45 offen offset:0 sc1
    buffer_load_dwordx4 v[76:79], v2, s[32:35], s45 offen offset:1024 sc1
    buffer_load_dwordx4 v[80:83], v2, s[32:35], s45 offen offset:2048 sc1
    buffer_load_dwordx4 v[84:87], v2, s[32:35], s45 offen offset:3072 sc1
    s_branch L_P3_CHK4
L_P3_RETRY5:
    s_add_u32 s55, s55, 1
    s_cmp_lt_u32 s55, 8192
    s_cbranch_scc0 L_P3_GIVEUP
    s_add_u32 s45, s44, 8192
    buffer_load_dwordx4 v[48:51], v2, s[32:35], s45 offen offset:2048 sc1
    buffer_load_dwordx4 v[52:55], v2, s[32:35], s45 offen offset:3072 sc1
    s_add_u32 s45, s45, 4096
    buffer_load_dwordx4 v[56:59], v2, s[32:35], s45 offen offset:0 sc1
    buffer_load_dwordx4 v[60:63], v2, s[32:35], s45 offen offset:1024 sc1
    buffer_load_dwordx4 v[64:67], v2, s[32:35], s45 offen offset:2048 sc1
    buffer_load_dwordx4 v[68:71], v2, s[32:35], s45 offen offset:3072 sc1
    s_add_u32 s45, s45, 4096
    buffer_load_dwordx4 v[72:75], v2, s[32:35], s45 offen offset:0 sc1
    buffer_load_dwordx4 v[76:79], v2, s[32:35], s45 offen offset:1024 sc1
    buffer_load_dwordx4 v[80:83], v2, s[32:35], s45 offen offset:2048 sc1
    buffer_load_dwordx4 v[84:87], v2, s[32:35], s45 offen offset:3072 sc1
    s_branch L_P3_CHK5
L_P3_RETRY6:
    s_add_u32 s55, s55, 1
    s_cmp_lt_u32 s55, 8192
    s_cbranch_scc0 L_P3_GIVEUP
    s_add_u32 s45, s44, 12288
    buffer_load_dwordx4 v[56:59], v2, s[32:35], s45 offen offset:0 sc1
    buffer_load_dwordx4 v[60:63], v2, s[32:35], s45 offen offset:1024 sc1
    buffer_load_dwordx4 v[64:67], v2, s[32:35], s45 offen offset:2048 sc1
    buffer_load_dwordx4 v[68:71], v2, s[32:35], s45 offen offset:3072 sc1
    s_add_u32 s45, s45, 4096
    buffer_load_dwordx4 v[72:75], v2, s[32:35], s45 offen offset:0 sc1
    buffer_load_dwordx4 v[76:79], v2, s[32:35], s45 offen offset:1024 sc1
    buffer_load_dwordx4 v[80:83], v2, s[32:35], s45 offen offset:2048 sc1
    buffer_load_dwordx4 v[84:87], v2, s[32:35], s45 offen offset:3072 sc1
    s_branch L_P3_CHK6
L_P3_RETRY7:
    s_add_u32 s55, s55, 1
    s_cmp_lt_u32 s55, 8192
    s_cbranch_scc0 L_P3_GIVEUP
    s_add_u32 s45, s44, 12288
    buffer_load_dwordx4 v[64:67], v2, s[32:35], s45 offen offset:2048 sc1
    buffer_load_dwordx4 v[68:71], v2, s[32:35], s45 offen offset:3072 sc1
    s_add_u32 s45, s45, 4096
    buffer_load_dwordx4 v[72:75], v2, s[32:35], s45 offen offset:0 sc1
    buffer_load_dwordx4 v[76:79], v2, s[32:35], s45 offen offset:1024 sc1
    buffer_load_dwordx4 v[80:83], v2, s[32:35], s45 offen offset:2048 sc1
    buffer_load_dwordx4 v[84:87], v2, s[32:35], s45 offen offset:3072 sc1
    s_branch L_P3_CHK7
L_P3_RETRY8:
    s_add_u32 s55, s55, 1
    s_cmp_lt_u32 s55, 8192
    s_cbranch_scc0 L_P3_GIVEUP
    s_add_u32 s45, s44, 16384
    buffer_load_dwordx4 v[72:75], v2, s[32:35], s45 offen offset:0 sc1
    buffer_load_dwordx4 v[76:79], v2, s[32:35], s45 offen offset:1024 sc1
    buffer_load_dwordx4 v[80:83], v2, s[32:35], s45 offen offset:2048 sc1
    buffer_load_dwordx4 v[84:87], v2, s[32:35], s45 offen offset:3072 sc1
    s_branch L_P3_CHK8
L_P3_RETRY9:
    s_add_u32 s55, s55, 1
    s_cmp_lt_u32 s55, 8192
    s_cbranch_scc0 L_P3_GIVEUP
    s_add_u32 s45, s44, 16384
    buffer_load_dwordx4 v[80:83], v2, s[32:35], s45 offen offset:2048 sc1
    buffer_load_dwordx4 v[84:87], v2, s[32:35], s45 offen offset:3072 sc1
    s_branch L_P3_CHK9
L_P3_GIVEUP:
    s_endpgm
.section .rodata,"a"
.p2align 6
.amdhsa_kernel recurrent_scan__mha_block__glu_gated_swiglu__prompt_kernel
  .amdhsa_next_free_vgpr 168
  .amdhsa_next_free_sgpr 102
  .amdhsa_accum_offset 168
  .amdhsa_group_segment_fixed_size 0
  .amdhsa_kernarg_size 80
  .amdhsa_user_sgpr_count 2
  .amdhsa_user_sgpr_kernarg_segment_ptr 1
  .amdhsa_system_sgpr_workgroup_id_x 1
.end_amdhsa_kernel
.p2align 6
.amdhsa_kernel attn_kernel
  .amdhsa_next_free_vgpr 168
  .amdhsa_next_free_sgpr 102
  .amdhsa_accum_offset 168
  .amdhsa_group_segment_fixed_size 0
  .amdhsa_kernarg_size 80
  .amdhsa_user_sgpr_count 2
  .amdhsa_user_sgpr_kernarg_segment_ptr 1
  .amdhsa_system_sgpr_workgroup_id_x 1
.end_amdhsa_kernel
```
